```python
import torch

def _softmax(x, axis=-1):
    return torch.softmax(x, dim=axis)
def _gelu(x):
    return torch.nn.functional.gelu(x, approximate="tanh")
def _silu(x):
    return torch.nn.functional.silu(x)
def _sigmoid(x):
    return torch.sigmoid(x)
def _layernorm(x, axis=-1, eps=1e-5):
    m = x.mean(dim=axis, keepdim=True)
    v = x.var(dim=axis, keepdim=True, unbiased=False)
    return (x - m) / torch.sqrt(v + eps)
def _scatter_add(tgt, idx, src, axis=0):
    return tgt.clone().index_add_(axis, idx, src)
def _segment_sum(src, seg, n):
    out = torch.zeros((n,) + src.shape[1:], dtype=src.dtype)
    return out.index_add_(0, seg, src)
def _pad(x, pw):
    flat = tuple(v for pair in reversed(pw) for v in pair)
    return torch.nn.functional.pad(x, flat)

kernel_name = 'sequential_preLN__linear_attn_block__dense_activation_gelu__prompt'

def setup_inputs():

    _w = (lambda a: (lambda t: t.to(torch.bfloat16) if t.is_floating_point() else t)(torch.as_tensor(a)))
    def _A_setup():
        B, S, D = 1, 2048, 448
        return {
            "x": _w((lambda *s: torch.randn(*s, dtype=torch.bfloat16) * 0.05)(B, S, D)),
            "wqkv": _w((lambda *s: torch.randn(*s, dtype=torch.bfloat16) * 0.1)(D, 3 * D)),
            "wo": _w((lambda *s: torch.randn(*s, dtype=torch.bfloat16) * 0.05)(D, D)),
        }
    _A_in = _A_setup()

    def _B_setup():
        B, S, D, F = 1, 2048, 448, 1792
        return {
            "x": _w((lambda *s: torch.randn(*s, dtype=torch.bfloat16) * 0.05)(B, S, D)),
            "w1": _w((lambda *s: torch.randn(*s, dtype=torch.bfloat16) * 0.8)(D, F) * (D ** -0.5)),
            "b1": _w((lambda *s: torch.randn(*s, dtype=torch.bfloat16) * 12.8)(F) * 0.01),
            "w2": _w((lambda *s: torch.randn(*s, dtype=torch.bfloat16) * 0.4)(F, D) * (F ** -0.5)),
            "b2": _w((lambda *s: torch.randn(*s, dtype=torch.bfloat16) * 6.4)(D) * 0.01),
        }
    _B_in = _B_setup()

    return {
        "A_x": _A_in["x"],
        "A_wqkv": _A_in["wqkv"],
        "A_wo": _A_in["wo"],
        "B_x": _B_in["x"],
        "B_w1": _B_in["w1"],
        "B_b1": _B_in["b1"],
        "B_w2": _B_in["w2"],
        "B_b2": _B_in["b2"],
    }

def reference(A_x, A_wqkv, A_wo, B_x, B_w1, B_b1, B_w2, B_b2):
    def _A_ref(x, wqkv, wo):
        B, S, D = x.shape
        H = 16; Dh = D // H
        qkv = (lambda x, *d: x.permute(*d))((x @ wqkv).reshape(B, S, 3, H, Dh), 2, 0, 3, 1, 4)
        q, k, v = qkv[0], qkv[1], qkv[2]
        phi = lambda t: torch.where(t > 0, t + 1, torch.exp(t)) + 1e-6
        pq, pk = phi(q), phi(k)
        kv = torch.einsum("bhsd,bhse->bhde", pk, v)
        z = torch.einsum("bhsd->bhd", pk)
        num = torch.einsum("bhqd,bhde->bhqe", pq, kv)
        den = torch.einsum("bhqd,bhd->bhq", pq, z)[..., None] + 1e-6
        o = num / den
        return (lambda x, *d: x.permute(*d))(o, 0, 2, 1, 3).reshape(B, S, D) @ wo

    def _B_ref(x, w1, b1, w2, b2):
        h = torch.einsum("bsd,df->bsf", x, w1) + b1
        h = _gelu(h)
        return torch.einsum("bsf,fd->bsd", h, w2) + b2

    x = A_x
    h = x + _A_ref(_layernorm(x, axis=-1), A_wqkv, A_wo)
    h2 = h + _B_ref(_layernorm(h, axis=-1), B_w1, B_b1, B_w2, B_b2)
    return h2
```

```asm
; @launch grid=(256,1,1) block=(512,1,1) lds=163840
.amdgcn_target "amdgcn-amd-amdhsa--gfx950"
.text
.globl sequential_preLN__linear_attn_block__dense_activation_gelu__prompt_kernel
.p2align 8
.type sequential_preLN__linear_attn_block__dense_activation_gelu__prompt_kernel,@function
sequential_preLN__linear_attn_block__dense_activation_gelu__prompt_kernel:
    s_cmp_ge_u32 s2, 256
    s_cbranch_scc0 Lgo_sequential_preLN__linear_attn_block__dense_activation_gelu__prompt_kernel
    s_endpgm
Lgo_sequential_preLN__linear_attn_block__dense_activation_gelu__prompt_kernel:
    s_load_dwordx16 s[48:63], s[0:1], 0
    s_load_dwordx4 s[84:87], s[0:1], 64
    s_load_dwordx2 s[72:73], s[0:1], 80
    s_getpc_b64 s[78:79]
Lpc0:
    s_mov_b32 s3, Lcode_end-Lpc0
    v_and_b32 v1, 63, v0
    v_lshrrev_b32 v2, 6, v0
    s_and_b32 s64, s2, 7
    s_lshr_b32 s65, s2, 3
    v_readfirstlane_b32 s67, v2
    s_nop 0
    s_and_b32 s66, s67, 3
    s_cmp_lt_u32 s67, 4
    s_cbranch_scc1 LprogX_sequential_preLN__linear_attn_block__dense_activation_gelu__prompt_kernel
    s_and_b32 s74, s65, 15
    s_lshr_b32 s75, s65, 4
    s_lshl_b32 s88, s64, 1
    s_add_u32 s75, s75, s88
    s_mul_i32 s77, s66, 24576
    s_add_u32 s77, s77, 57344
    s_mov_b32 s10, 1835008
    s_mov_b32 s11, 0x00020000
    s_mov_b32 s14, 1204224
    s_mov_b32 s15, 0x00020000
    s_lshl_b32 s88, s75, 7
    s_lshl_b32 s89, s66, 5
    s_add_u32 s88, s88, s89
    s_mul_i32 s76, s88, 896
    s_mul_i32 s92, s74, 56
    s_and_b32 s92, s92, 0xfffffff0
    s_mul_i32 s89, s66, 43008
    s_add_u32 s80, s89, s92
    s_lshl_b32 s81, s66, 11
    v_lshrrev_b32 v8, 3, v1
    v_mul_u32_u24 v11, 896, v8
    v_and_b32 v9, 7, v1
    v_lshrrev_b32 v10, 4, v1
    v_xor_b32 v9, v9, v10
    v_lshl_add_u32 v2, v9, 4, v11
    v_xor_b32 v9, 4, v9
    v_lshl_add_u32 v3, v9, 4, v11
    v_mul_u32_u24 v4, 2688, v8
    v_bfe_u32 v9, v1, 2, 1
    v_bfe_u32 v10, v1, 4, 1
    v_xor_b32 v9, v9, v10
    v_mul_u32_u24 v9, 896, v9
    v_and_b32 v10, 3, v1
    v_lshl_add_u32 v9, v10, 4, v9
    v_add3_u32 v4, v4, v9, v9
    v_sub_u32 v4, v4, v9
    v_add_u32 v4, 896, v4
    s_mul_i32 s96, s74, 3
    s_lshr_b32 s88, s65, 4
    s_mul_i32 s88, s88, 5
    s_add_u32 s96, s96, s88
    s_mul_i32 s88, s96, 9363
    s_lshr_b32 s88, s88, 16
    s_mul_i32 s88, s88, 7
    s_sub_u32 s96, s96, s88
    s_add_u32 s97, s96, 0
    s_cmp_ge_u32 s97, 7
    s_cselect_b32 s89, 7, 0
    s_sub_u32 s97, s97, s89
    s_lshl_b32 s91, s97, 7
    s_add_u32 s91, s91, s76
    s_mul_i32 s97, s97, 172032
    s_add_u32 s97, s97, s80
    s_waitcnt lgkmcnt(0)
    s_mov_b32 s8, s48
    s_mov_b32 s9, s49
    s_mov_b32 s12, s50
    s_mov_b32 s13, s51
    s_add_u32 m0, s81, 0
    s_nop 0
    buffer_load_dwordx4 v4, s[12:15], s97 offen  lds
    s_add_u32 m0, s81, 1024
    s_add_u32 s88, s97, 21504
    buffer_load_dwordx4 v4, s[12:15], s88 offen  lds
    s_add_u32 m0, s77, 0
    s_nop 0
    buffer_load_dwordx4 v2, s[8:11], s91 offen  lds
    s_add_u32 m0, s77, 1024
    s_add_u32 s88, s91, 7168
    buffer_load_dwordx4 v3, s[8:11], s88 offen  lds
    s_add_u32 m0, s77, 2048
    s_add_u32 s88, s91, 14336
    buffer_load_dwordx4 v2, s[8:11], s88 offen  lds
    s_add_u32 m0, s77, 3072
    s_add_u32 s88, s91, 21504
    buffer_load_dwordx4 v3, s[8:11], s88 offen  lds
    s_add_u32 s97, s96, 1
    s_cmp_ge_u32 s97, 7
    s_cselect_b32 s89, 7, 0
    s_sub_u32 s97, s97, s89
    s_lshl_b32 s91, s97, 7
    s_add_u32 s91, s91, s76
    s_mul_i32 s97, s97, 172032
    s_add_u32 s97, s97, s80
    s_add_u32 m0, s81, 8192
    s_nop 0
    buffer_load_dwordx4 v4, s[12:15], s97 offen  lds
    s_add_u32 m0, s81, 9216
    s_add_u32 s88, s97, 21504
    buffer_load_dwordx4 v4, s[12:15], s88 offen  lds
    s_add_u32 m0, s77, 4096
    s_nop 0
    buffer_load_dwordx4 v2, s[8:11], s91 offen  lds
    s_add_u32 m0, s77, 5120
    s_add_u32 s88, s91, 7168
    buffer_load_dwordx4 v3, s[8:11], s88 offen  lds
    s_add_u32 m0, s77, 6144
    s_add_u32 s88, s91, 14336
    buffer_load_dwordx4 v2, s[8:11], s88 offen  lds
    s_add_u32 m0, s77, 7168
    s_add_u32 s88, s91, 21504
    buffer_load_dwordx4 v3, s[8:11], s88 offen  lds
    s_waitcnt vmcnt(6)
    s_barrier
    s_add_u32 s97, s96, 2
    s_cmp_ge_u32 s97, 7
    s_cselect_b32 s89, 7, 0
    s_sub_u32 s97, s97, s89
    s_lshl_b32 s91, s97, 7
    s_add_u32 s91, s91, s76
    s_mul_i32 s97, s97, 172032
    s_add_u32 s97, s97, s80
    s_add_u32 m0, s81, 16384
    s_nop 0
    buffer_load_dwordx4 v4, s[12:15], s97 offen  lds
    s_add_u32 m0, s81, 17408
    s_add_u32 s88, s97, 21504
    buffer_load_dwordx4 v4, s[12:15], s88 offen  lds
    s_add_u32 m0, s77, 8192
    s_nop 0
    buffer_load_dwordx4 v2, s[8:11], s91 offen  lds
    s_add_u32 m0, s77, 9216
    s_add_u32 s88, s91, 7168
    buffer_load_dwordx4 v3, s[8:11], s88 offen  lds
    s_add_u32 m0, s77, 10240
    s_add_u32 s88, s91, 14336
    buffer_load_dwordx4 v2, s[8:11], s88 offen  lds
    s_add_u32 m0, s77, 11264
    s_add_u32 s88, s91, 21504
    buffer_load_dwordx4 v3, s[8:11], s88 offen  lds
    s_waitcnt vmcnt(6)
    s_barrier
    s_add_u32 s97, s96, 3
    s_cmp_ge_u32 s97, 7
    s_cselect_b32 s89, 7, 0
    s_sub_u32 s97, s97, s89
    s_lshl_b32 s91, s97, 7
    s_add_u32 s91, s91, s76
    s_mul_i32 s97, s97, 172032
    s_add_u32 s97, s97, s80
    s_add_u32 m0, s81, 24576
    s_nop 0
    buffer_load_dwordx4 v4, s[12:15], s97 offen  lds
    s_add_u32 m0, s81, 25600
    s_add_u32 s88, s97, 21504
    buffer_load_dwordx4 v4, s[12:15], s88 offen  lds
    s_add_u32 m0, s77, 12288
    s_nop 0
    buffer_load_dwordx4 v2, s[8:11], s91 offen  lds
    s_add_u32 m0, s77, 13312
    s_add_u32 s88, s91, 7168
    buffer_load_dwordx4 v3, s[8:11], s88 offen  lds
    s_add_u32 m0, s77, 14336
    s_add_u32 s88, s91, 14336
    buffer_load_dwordx4 v2, s[8:11], s88 offen  lds
    s_add_u32 m0, s77, 15360
    s_add_u32 s88, s91, 21504
    buffer_load_dwordx4 v3, s[8:11], s88 offen  lds
    s_waitcnt vmcnt(6)
    s_barrier
    s_add_u32 s97, s96, 4
    s_cmp_ge_u32 s97, 7
    s_cselect_b32 s89, 7, 0
    s_sub_u32 s97, s97, s89
    s_lshl_b32 s91, s97, 7
    s_add_u32 s91, s91, s76
    s_mul_i32 s97, s97, 172032
    s_add_u32 s97, s97, s80
    s_add_u32 m0, s81, 32768
    s_nop 0
    buffer_load_dwordx4 v4, s[12:15], s97 offen  lds
    s_add_u32 m0, s81, 33792
    s_add_u32 s88, s97, 21504
    buffer_load_dwordx4 v4, s[12:15], s88 offen  lds
    s_add_u32 m0, s77, 16384
    s_nop 0
    buffer_load_dwordx4 v2, s[8:11], s91 offen  lds
    s_add_u32 m0, s77, 17408
    s_add_u32 s88, s91, 7168
    buffer_load_dwordx4 v3, s[8:11], s88 offen  lds
    s_add_u32 m0, s77, 18432
    s_add_u32 s88, s91, 14336
    buffer_load_dwordx4 v2, s[8:11], s88 offen  lds
    s_add_u32 m0, s77, 19456
    s_add_u32 s88, s91, 21504
    buffer_load_dwordx4 v3, s[8:11], s88 offen  lds
    s_waitcnt vmcnt(6)
    s_barrier
    s_add_u32 s97, s96, 5
    s_cmp_ge_u32 s97, 7
    s_cselect_b32 s89, 7, 0
    s_sub_u32 s97, s97, s89
    s_lshl_b32 s91, s97, 7
    s_add_u32 s91, s91, s76
    s_mul_i32 s97, s97, 172032
    s_add_u32 s97, s97, s80
    s_add_u32 m0, s81, 40960
    s_nop 0
    buffer_load_dwordx4 v4, s[12:15], s97 offen  lds
    s_add_u32 m0, s81, 41984
    s_add_u32 s88, s97, 21504
    buffer_load_dwordx4 v4, s[12:15], s88 offen  lds
    s_add_u32 m0, s77, 20480
    s_nop 0
    buffer_load_dwordx4 v2, s[8:11], s91 offen  lds
    s_add_u32 m0, s77, 21504
    s_add_u32 s88, s91, 7168
    buffer_load_dwordx4 v3, s[8:11], s88 offen  lds
    s_add_u32 m0, s77, 22528
    s_add_u32 s88, s91, 14336
    buffer_load_dwordx4 v2, s[8:11], s88 offen  lds
    s_add_u32 m0, s77, 23552
    s_add_u32 s88, s91, 21504
    buffer_load_dwordx4 v3, s[8:11], s88 offen  lds
    s_waitcnt vmcnt(6)
    s_barrier
    s_add_u32 s97, s96, 6
    s_cmp_ge_u32 s97, 7
    s_cselect_b32 s89, 7, 0
    s_sub_u32 s97, s97, s89
    s_lshl_b32 s91, s97, 7
    s_add_u32 s91, s91, s76
    s_mul_i32 s97, s97, 172032
    s_add_u32 s97, s97, s80
    s_add_u32 m0, s81, 49152
    s_nop 0
    buffer_load_dwordx4 v4, s[12:15], s97 offen  lds
    s_add_u32 m0, s81, 50176
    s_add_u32 s88, s97, 21504
    buffer_load_dwordx4 v4, s[12:15], s88 offen  lds
    s_add_u32 m0, s77, 0
    s_nop 0
    buffer_load_dwordx4 v2, s[8:11], s91 offen  lds
    s_add_u32 m0, s77, 1024
    s_add_u32 s88, s91, 7168
    buffer_load_dwordx4 v3, s[8:11], s88 offen  lds
    s_add_u32 m0, s77, 2048
    s_add_u32 s88, s91, 14336
    buffer_load_dwordx4 v2, s[8:11], s88 offen  lds
    s_add_u32 m0, s77, 3072
    s_add_u32 s88, s91, 21504
    buffer_load_dwordx4 v3, s[8:11], s88 offen  lds
    s_waitcnt vmcnt(6)
    s_barrier
    s_mov_b32 s44, s72
    s_mov_b32 s45, s73
    s_mov_b32 s46, 268435456
    s_mov_b32 s47, 0x00020000
    s_mov_b32 s40, s86
    s_mov_b32 s41, s87
    s_mov_b32 s42, 256
    s_mov_b32 s43, 0x00020000
    s_mov_b32 s16, s52
    s_mov_b32 s17, s53
    s_mov_b32 s18, 401408
    s_mov_b32 s19, 0x00020000
    s_mov_b32 s20, s56
    s_mov_b32 s21, s57
    s_mov_b32 s22, 1605632
    s_mov_b32 s23, 0x00020000
    s_mov_b32 s24, s58
    s_mov_b32 s25, s59
    s_mov_b32 s26, 3584
    s_mov_b32 s27, 0x00020000
    s_mov_b32 s28, s60
    s_mov_b32 s29, s61
    s_mov_b32 s30, 1605632
    s_mov_b32 s31, 0x00020000
    s_mov_b32 s32, s62
    s_mov_b32 s33, s63
    s_mov_b32 s34, 896
    s_mov_b32 s35, 0x00020000
    s_mov_b32 s36, s84
    s_mov_b32 s37, s85
    s_mov_b32 s38, 1835008
    s_mov_b32 s39, 0x00020000
    s_mov_b32 s4, s72
    s_mov_b32 s5, s73
    s_mov_b32 s6, 268435456
    s_mov_b32 s7, 0x00020000
    s_mov_b32 s68, s72
    s_mov_b32 s69, s73
    s_mov_b32 s70, 0
    s_mov_b32 s71, 0x00020000
    s_lshl_b32 s67, s64, 12
    s_add_u32 s67, s67, 65536
    s_and_b32 s89, s66, 1
    s_mul_i32 s82, s89, 14
    s_mul_i32 s83, s89, 24576
    s_add_u32 s83, s83, 110592
    v_lshrrev_b32 v8, 2, v1
    v_mul_u32_u24 v5, 2688, v8
    v_and_b32 v10, 3, v1
    v_lshl_add_u32 v5, v10, 4, v5
    s_and_b32 s88, s74, 1
    s_lshl_b32 s88, s88, 3
    v_lshrrev_b32 v14, 5, v1
    v_bfe_u32 v15, v1, 2, 2
    v_lshl_add_u32 v14, v14, 3, v15
    v_lshlrev_b32 v10, 7, v14
    v_bfe_u32 v15, v1, 3, 1
    v_lshl_add_u32 v10, v15, 6, v10
    v_bfe_u32 v15, v1, 4, 1
    v_lshl_add_u32 v10, v15, 5, v10
    v_and_b32 v13, 3, v1
    v_lshl_add_u32 v10, v13, 3, v10
    v_xor_b32 v11, 64, v10
    v_and_b32 v13, 0x13, v1
    v_cmp_eq_u32 vcc, 0x13, v13
    s_nop 1
    v_cndmask_b32 v13, 0, -8, vcc
    v_add_u32 v13, s88, v13
    v_add_u32 v10, v13, v10
    v_add_u32 v11, v13, v11
    v_lshlrev_b32 v125, 6, v14
    v_lshl_add_u32 v125, v15, 5, v125
    v_add_u32 v125, v13, v125
    v_and_b32 v13, 1, v1
    v_lshl_add_u32 v125, v13, 4, v125
    v_bfe_u32 v13, v1, 1, 1
    v_lshl_add_u32 v125, v13, 3, v125
    s_and_b32 s88, s66, 1
    s_mul_i32 s88, s88, 24576
    s_add_u32 s88, s88, 110592
    v_add_u32 v125, s88, v125
    v_lshrrev_b32 v112, 4, v1
    v_xor_b32 v112, v112, v1
    v_and_b32 v112, 1, v112
    v_cmp_eq_u32 vcc, 0, v112
    v_mov_b32 v112, 0x3f803f80
    s_nop 0
    v_cndmask_b32 v16, 0, v112, vcc
    v_cndmask_b32 v17, 0, v112, vcc
    v_cndmask_b32 v18, 0, v112, vcc
    v_cndmask_b32 v19, 0, v112, vcc
    s_lshl_b32 s88, s66, 11
    v_add_u32 v10, s88, v10
    v_add_u32 v11, s88, v11
    s_and_b32 s55, s65, 3
    s_mul_i32 s55, s55, 224
    s_and_b32 s89, s66, 1
    s_lshl_b32 s56, s89, 10
    s_lshl_b32 s88, s89, 6
    v_add_u32 v115, s88, v1
    v_add_u32 v112, 0, v115
    v_mul_u32_u24 v113, 4682, v112
    v_lshrrev_b32 v113, 16, v113
    v_mul_u32_u24 v114, 14, v113
    v_sub_u32 v112, v112, v114
    v_mul_u32_u24 v113, 896, v113
    v_lshl_add_u32 v96, v112, 4, v113
    v_add_u32 v112, 128, v115
    v_mul_u32_u24 v113, 4682, v112
    v_lshrrev_b32 v113, 16, v113
    v_mul_u32_u24 v114, 14, v113
    v_sub_u32 v112, v112, v114
    v_mul_u32_u24 v113, 896, v113
    v_lshl_add_u32 v97, v112, 4, v113
    v_add_u32 v112, 256, v115
    v_mul_u32_u24 v113, 4682, v112
    v_lshrrev_b32 v113, 16, v113
    v_mul_u32_u24 v114, 14, v113
    v_sub_u32 v112, v112, v114
    v_mul_u32_u24 v113, 896, v113
    v_lshl_add_u32 v98, v112, 4, v113
    v_add_u32 v112, 384, v115
    v_mul_u32_u24 v113, 4682, v112
    v_lshrrev_b32 v113, 16, v113
    v_mul_u32_u24 v114, 14, v113
    v_sub_u32 v112, v112, v114
    v_mul_u32_u24 v113, 896, v113
    v_lshl_add_u32 v99, v112, 4, v113
    v_add_u32 v112, 512, v115
    v_mul_u32_u24 v113, 4682, v112
    v_lshrrev_b32 v113, 16, v113
    v_mul_u32_u24 v114, 14, v113
    v_sub_u32 v112, v112, v114
    v_mul_u32_u24 v113, 896, v113
    v_lshl_add_u32 v100, v112, 4, v113
    v_add_u32 v112, 640, v115
    v_mul_u32_u24 v113, 4682, v112
    v_lshrrev_b32 v113, 16, v113
    v_mul_u32_u24 v114, 14, v113
    v_sub_u32 v112, v112, v114
    v_mul_u32_u24 v113, 896, v113
    v_lshl_add_u32 v101, v112, 4, v113
    v_add_u32 v112, 768, v115
    v_mul_u32_u24 v113, 4682, v112
    v_lshrrev_b32 v113, 16, v113
    v_mul_u32_u24 v114, 14, v113
    v_sub_u32 v112, v112, v114
    v_mul_u32_u24 v113, 896, v113
    v_lshl_add_u32 v102, v112, 4, v113
    v_and_b32 v127, 7, v1
    v_lshlrev_b32 v127, 5, v127
    buffer_load_dword v126, v127, s[40:43], 0 offen sc1
    ds_read_b64_tr_b16 v[24:25], v10 offset:0
    ds_read_b64_tr_b16 v[26:27], v10 offset:512
    ds_read_b64_tr_b16 v[28:29], v11 offset:0
    ds_read_b64_tr_b16 v[30:31], v11 offset:512
    ds_read_b64_tr_b16 v[32:33], v10 offset:8192
    ds_read_b64_tr_b16 v[34:35], v10 offset:8704
    ds_read_b64_tr_b16 v[36:37], v11 offset:8192
    ds_read_b64_tr_b16 v[38:39], v11 offset:8704
    ds_read_b64_tr_b16 v[40:41], v10 offset:16384
    ds_read_b64_tr_b16 v[42:43], v10 offset:16896
    ds_read_b64_tr_b16 v[44:45], v11 offset:16384
    ds_read_b64_tr_b16 v[46:47], v11 offset:16896
    s_cmp_lt_u32 s66, 2
    s_cbranch_scc1 L_sequential_preLN__linear_attn_block__dense_activation_gelu__prompt_kernel_1
L_sequential_preLN__linear_attn_block__dense_activation_gelu__prompt_kernel_1:
    s_waitcnt vmcnt(1)
    s_barrier
    ds_read_b64_tr_b16 v[72:73], v10 offset:49152
    ds_read_b64_tr_b16 v[74:75], v10 offset:49664
    ds_read_b64_tr_b16 v[76:77], v11 offset:49152
    ds_read_b64_tr_b16 v[78:79], v11 offset:49664
    s_cmp_lt_u32 s66, 2
    s_cbranch_scc1 L_sequential_preLN__linear_attn_block__dense_activation_gelu__prompt_kernel_2
    s_add_u32 s88, s82, 0
    s_lshr_b32 s89, s88, 2
    s_add_u32 s89, s89, s96
    s_cmp_ge_u32 s89, 7
    s_cselect_b32 s90, 7, 0
    s_sub_u32 s89, s89, s90
    s_lshl_b32 s89, s89, 2
    s_and_b32 s88, s88, 3
    s_add_u32 s88, s88, s89
    s_mul_i32 s88, s88, 43008
    s_add_u32 s97, s88, s92
    s_add_u32 m0, s83, 0
    s_nop 0
    buffer_load_dwordx4 v5, s[12:15], s97 offen  lds
    s_add_u32 s88, s82, 1
    s_lshr_b32 s89, s88, 2
    s_add_u32 s89, s89, s96
    s_cmp_ge_u32 s89, 7
    s_cselect_b32 s90, 7, 0
    s_sub_u32 s89, s89, s90
    s_lshl_b32 s89, s89, 2
    s_and_b32 s88, s88, 3
    s_add_u32 s88, s88, s89
    s_mul_i32 s88, s88, 43008
    s_add_u32 s97, s88, s92
    s_add_u32 m0, s83, 1024
    s_nop 0
    buffer_load_dwordx4 v5, s[12:15], s97 offen  lds
    s_add_u32 s88, s82, 2
    s_lshr_b32 s89, s88, 2
    s_add_u32 s89, s89, s96
    s_cmp_ge_u32 s89, 7
    s_cselect_b32 s90, 7, 0
    s_sub_u32 s89, s89, s90
    s_lshl_b32 s89, s89, 2
    s_and_b32 s88, s88, 3
    s_add_u32 s88, s88, s89
    s_mul_i32 s88, s88, 43008
    s_add_u32 s97, s88, s92
    s_add_u32 m0, s83, 2048
    s_nop 0
    buffer_load_dwordx4 v5, s[12:15], s97 offen  lds
    s_add_u32 s88, s82, 3
    s_lshr_b32 s89, s88, 2
    s_add_u32 s89, s89, s96
    s_cmp_ge_u32 s89, 7
    s_cselect_b32 s90, 7, 0
    s_sub_u32 s89, s89, s90
    s_lshl_b32 s89, s89, 2
    s_and_b32 s88, s88, 3
    s_add_u32 s88, s88, s89
    s_mul_i32 s88, s88, 43008
    s_add_u32 s97, s88, s92
    s_add_u32 m0, s83, 3072
    s_nop 0
    buffer_load_dwordx4 v5, s[12:15], s97 offen  lds
    s_add_u32 s88, s82, 4
    s_lshr_b32 s89, s88, 2
    s_add_u32 s89, s89, s96
    s_cmp_ge_u32 s89, 7
    s_cselect_b32 s90, 7, 0
    s_sub_u32 s89, s89, s90
    s_lshl_b32 s89, s89, 2
    s_and_b32 s88, s88, 3
    s_add_u32 s88, s88, s89
    s_mul_i32 s88, s88, 43008
    s_add_u32 s97, s88, s92
    s_add_u32 m0, s83, 4096
    s_nop 0
    buffer_load_dwordx4 v5, s[12:15], s97 offen  lds
    s_add_u32 s88, s82, 5
    s_lshr_b32 s89, s88, 2
    s_add_u32 s89, s89, s96
    s_cmp_ge_u32 s89, 7
    s_cselect_b32 s90, 7, 0
    s_sub_u32 s89, s89, s90
    s_lshl_b32 s89, s89, 2
    s_and_b32 s88, s88, 3
    s_add_u32 s88, s88, s89
    s_mul_i32 s88, s88, 43008
    s_add_u32 s97, s88, s92
    s_add_u32 m0, s83, 5120
    s_nop 0
    buffer_load_dwordx4 v5, s[12:15], s97 offen  lds
    s_add_u32 s88, s82, 6
    s_lshr_b32 s89, s88, 2
    s_add_u32 s89, s89, s96
    s_cmp_ge_u32 s89, 7
    s_cselect_b32 s90, 7, 0
    s_sub_u32 s89, s89, s90
    s_lshl_b32 s89, s89, 2
    s_and_b32 s88, s88, 3
    s_add_u32 s88, s88, s89
    s_mul_i32 s88, s88, 43008
    s_add_u32 s97, s88, s92
    s_add_u32 m0, s83, 6144
    s_nop 0
    buffer_load_dwordx4 v5, s[12:15], s97 offen  lds
    s_add_u32 s88, s82, 7
    s_lshr_b32 s89, s88, 2
    s_add_u32 s89, s89, s96
    s_cmp_ge_u32 s89, 7
    s_cselect_b32 s90, 7, 0
    s_sub_u32 s89, s89, s90
    s_lshl_b32 s89, s89, 2
    s_and_b32 s88, s88, 3
    s_add_u32 s88, s88, s89
    s_mul_i32 s88, s88, 43008
    s_add_u32 s97, s88, s92
    s_add_u32 m0, s83, 7168
    s_nop 0
    buffer_load_dwordx4 v5, s[12:15], s97 offen  lds
    s_add_u32 s88, s82, 8
    s_lshr_b32 s89, s88, 2
    s_add_u32 s89, s89, s96
    s_cmp_ge_u32 s89, 7
    s_cselect_b32 s90, 7, 0
    s_sub_u32 s89, s89, s90
    s_lshl_b32 s89, s89, 2
    s_and_b32 s88, s88, 3
    s_add_u32 s88, s88, s89
    s_mul_i32 s88, s88, 43008
    s_add_u32 s97, s88, s92
    s_add_u32 m0, s83, 8192
    s_nop 0
    buffer_load_dwordx4 v5, s[12:15], s97 offen  lds
    s_add_u32 s88, s82, 9
    s_lshr_b32 s89, s88, 2
    s_add_u32 s89, s89, s96
    s_cmp_ge_u32 s89, 7
    s_cselect_b32 s90, 7, 0
    s_sub_u32 s89, s89, s90
    s_lshl_b32 s89, s89, 2
    s_and_b32 s88, s88, 3
    s_add_u32 s88, s88, s89
    s_mul_i32 s88, s88, 43008
    s_add_u32 s97, s88, s92
    s_add_u32 m0, s83, 9216
    s_nop 0
    buffer_load_dwordx4 v5, s[12:15], s97 offen  lds
    s_add_u32 s88, s82, 10
    s_lshr_b32 s89, s88, 2
    s_add_u32 s89, s89, s96
    s_cmp_ge_u32 s89, 7
    s_cselect_b32 s90, 7, 0
    s_sub_u32 s89, s89, s90
    s_lshl_b32 s89, s89, 2
    s_and_b32 s88, s88, 3
    s_add_u32 s88, s88, s89
    s_mul_i32 s88, s88, 43008
    s_add_u32 s97, s88, s92
    s_add_u32 m0, s83, 10240
    s_nop 0
    buffer_load_dwordx4 v5, s[12:15], s97 offen  lds
    s_add_u32 s88, s82, 11
    s_lshr_b32 s89, s88, 2
    s_add_u32 s89, s89, s96
    s_cmp_ge_u32 s89, 7
    s_cselect_b32 s90, 7, 0
    s_sub_u32 s89, s89, s90
    s_lshl_b32 s89, s89, 2
    s_and_b32 s88, s88, 3
    s_add_u32 s88, s88, s89
    s_mul_i32 s88, s88, 43008
    s_add_u32 s97, s88, s92
    s_add_u32 m0, s83, 11264
    s_nop 0
    buffer_load_dwordx4 v5, s[12:15], s97 offen  lds
    s_add_u32 s88, s82, 12
    s_lshr_b32 s89, s88, 2
    s_add_u32 s89, s89, s96
    s_cmp_ge_u32 s89, 7
    s_cselect_b32 s90, 7, 0
    s_sub_u32 s89, s89, s90
    s_lshl_b32 s89, s89, 2
    s_and_b32 s88, s88, 3
    s_add_u32 s88, s88, s89
    s_mul_i32 s88, s88, 43008
    s_add_u32 s97, s88, s92
    s_add_u32 m0, s83, 12288
    s_nop 0
    buffer_load_dwordx4 v5, s[12:15], s97 offen  lds
    s_add_u32 s88, s82, 13
    s_lshr_b32 s89, s88, 2
    s_add_u32 s89, s89, s96
    s_cmp_ge_u32 s89, 7
    s_cselect_b32 s90, 7, 0
    s_sub_u32 s89, s89, s90
    s_lshl_b32 s89, s89, 2
    s_and_b32 s88, s88, 3
    s_add_u32 s88, s88, s89
    s_mul_i32 s88, s88, 43008
    s_add_u32 s97, s88, s92
    s_add_u32 m0, s83, 13312
    s_nop 0
    buffer_load_dwordx4 v5, s[12:15], s97 offen  lds
L_sequential_preLN__linear_attn_block__dense_activation_gelu__prompt_kernel_2:
    s_waitcnt lgkmcnt(12)
    v_mfma_f32_16x16x32_bf16 v[80:83], v[16:19], v[24:27], 0
    v_mfma_f32_16x16x32_bf16 v[84:87], v[16:19], v[28:31], 0
    ds_read_b64_tr_b16 v[48:49], v10 offset:24576
    ds_read_b64_tr_b16 v[50:51], v10 offset:25088
    ds_read_b64_tr_b16 v[52:53], v11 offset:24576
    ds_read_b64_tr_b16 v[54:55], v11 offset:25088
    s_waitcnt lgkmcnt(12)
    v_mfma_f32_16x16x32_bf16 v[80:83], v[16:19], v[32:35], v[80:83]
    v_mfma_f32_16x16x32_bf16 v[84:87], v[16:19], v[36:39], v[84:87]
    ds_read_b64_tr_b16 v[56:57], v10 offset:32768
    ds_read_b64_tr_b16 v[58:59], v10 offset:33280
    ds_read_b64_tr_b16 v[60:61], v11 offset:32768
    ds_read_b64_tr_b16 v[62:63], v11 offset:33280
    s_waitcnt lgkmcnt(12)
    v_mfma_f32_16x16x32_bf16 v[80:83], v[16:19], v[40:43], v[80:83]
    v_mfma_f32_16x16x32_bf16 v[84:87], v[16:19], v[44:47], v[84:87]
    ds_read_b64_tr_b16 v[64:65], v10 offset:40960
    ds_read_b64_tr_b16 v[66:67], v10 offset:41472
    ds_read_b64_tr_b16 v[68:69], v11 offset:40960
    ds_read_b64_tr_b16 v[70:71], v11 offset:41472
    s_waitcnt lgkmcnt(12)
    v_mfma_f32_16x16x32_bf16 v[80:83], v[16:19], v[72:75], v[80:83]
    v_mfma_f32_16x16x32_bf16 v[84:87], v[16:19], v[76:79], v[84:87]
    s_waitcnt lgkmcnt(8)
    v_mfma_f32_16x16x32_bf16 v[80:83], v[16:19], v[48:51], v[80:83]
    v_mfma_f32_16x16x32_bf16 v[84:87], v[16:19], v[52:55], v[84:87]
    s_waitcnt lgkmcnt(4)
    v_mfma_f32_16x16x32_bf16 v[80:83], v[16:19], v[56:59], v[80:83]
    v_mfma_f32_16x16x32_bf16 v[84:87], v[16:19], v[60:63], v[84:87]
    s_waitcnt lgkmcnt(0)
    v_mfma_f32_16x16x32_bf16 v[80:83], v[16:19], v[64:67], v[80:83]
    v_mfma_f32_16x16x32_bf16 v[84:87], v[16:19], v[68:71], v[84:87]
    v_cmp_gt_u32 vcc, 32, v1
    s_lshl_b32 s88, s66, 8
    v_lshlrev_b32 v113, 2, v1
    v_add_u32 v113, s88, v113
    v_add_u32 v113, 156672, v113
    v_bfe_u32 v112, v1, 4, 1
    v_cmp_eq_u32 s[94:95], 1, v112
    s_nop 1
    v_cndmask_b32 v80, v80, v81, s[94:95]
    v_cndmask_b32 v84, v84, v85, s[94:95]
    v_cndmask_b32 v80, v84, v80, vcc
    ds_write_b32 v113, v80
    s_waitcnt lgkmcnt(0)
    s_barrier
    s_lshr_b32 s76, s65, 2
    s_lshl_b32 s88, s64, 3
    s_add_u32 s76, s76, s88
    s_and_b32 s77, s65, 3
    s_lshl_b32 s88, s66, 6
    v_lshlrev_b32 v10, 4, v1
    v_lshrrev_b32 v112, 2, v1
    v_mul_u32_u24 v9, 224, v112
    v_and_b32 v112, 3, v1
    v_lshl_add_u32 v9, v112, 3, v9
    v_add_u32 v9, s88, v9
    v_add_u32 v8, 50176, v9
    s_lshl_b32 s88, s66, 11
    v_lshlrev_b32 v11, 2, v1
    v_add_u32 v11, s88, v11
    v_add_u32 v12, 106496, v11
    s_lshl_b32 s78, s74, 12
    v_and_b32 v112, 15, v1
    v_mul_u32_u24 v112, 224, v112
    v_lshrrev_b32 v113, 4, v1
    v_lshl_add_u32 v7, v113, 3, v112
    s_mul_i32 s88, s76, 28672
    s_mul_i32 s89, s77, 224
    s_add_u32 s48, s88, s89
    s_lshl_b32 s89, s66, 6
    s_add_u32 s89, s89, 94208
    v_add_u32 v7, s89, v7
    s_lshl_b32 s79, s66, 14
    s_lshl_b32 s88, s76, 15
    s_lshl_b32 s89, s66, 12
    s_add_u32 s80, s88, s89
    s_add_u32 s80, s80, 1048576
    s_add_u32 s81, s80, 16384
    s_mov_b32 s82, 0x358637bd
    s_lshl_b32 s83, s66, 13
    v_add_u32 v6, s83, v10
    s_mov_b32 s91, 98304
    s_lshr_b32 s88, s65, 4
    s_lshl_b32 s88, s88, 8
    s_add_u32 s92, s67, s88
    v_and_b32 v2, 7, v1
    v_lshlrev_b32 v2, 7, v2
    v_lshlrev_b32 v3, 2, v1
    v_and_b32 v4, 31, v1
    v_lshlrev_b32 v4, 4, v4
    s_mov_b64 s[96:97], -1
    s_mul_i32 s88, s76, 28
    s_mul_i32 s89, s77, 7
    s_add_u32 s88, s88, s89
    s_lshl_b32 s89, s66, 1
    s_add_u32 s88, s88, s89
    s_lshl_b32 s88, s88, 10
    s_add_u32 s50, s88, 3145728
    s_mov_b32 s51, 0xffff0000
    s_lshl_b32 s53, s65, 13
    s_add_u32 s53, s53, 786432
    s_mov_b32 s54, 3
    v_lshlrev_b32 v5, 7, v1
    v_lshrrev_b32 v112, 5, v1
    v_lshlrev_b32 v13, 10, v112
    v_lshlrev_b32 v14, 9, v112
    v_bfe_u32 v112, v1, 4, 1
    v_lshl_add_u32 v13, v112, 9, v13
    v_lshl_add_u32 v14, v112, 3, v14
    v_and_b32 v112, 15, v1
    v_lshl_add_u32 v13, v112, 4, v13
    v_lshl_add_u32 v14, v112, 4, v14
    v_lshlrev_b32 v15, 4, v1
    v_mov_b32 v112, 2130706432
    v_cmp_gt_u32 vcc, 32, v1
    s_nop 1
    v_cndmask_b32 v15, v112, v15, vcc
    s_lshl_b32 s88, s76, 12
    s_lshl_b32 s89, s77, 10
    s_add_u32 s88, s88, s89
    s_lshr_b32 s89, s66, 1
    s_lshl_b32 s89, s89, 9
    s_add_u32 s88, s88, s89
    s_and_b32 s89, s66, 1
    s_lshl_b32 s89, s89, 3
    s_add_u32 s88, s88, s89
    s_add_u32 s52, s88, 5242880
    s_cmp_ge_u32 s66, 2
    s_cbranch_scc1 L_sequential_preLN__linear_attn_block__dense_activation_gelu__prompt_kernel_3
    s_waitcnt vmcnt(0)
    s_mov_b32 s99, 0
    s_branch L_sequential_preLN__linear_attn_block__dense_activation_gelu__prompt_kernel_4_c
L_sequential_preLN__linear_attn_block__dense_activation_gelu__prompt_kernel_4:
    buffer_load_dword v126, v127, s[40:43], 0 offen sc1
    s_add_u32 s99, s99, 1
    s_waitcnt vmcnt(0)
L_sequential_preLN__linear_attn_block__dense_activation_gelu__prompt_kernel_4_c:
    v_cmp_ne_u32 vcc, 0, v126
    s_cmp_gt_u32 s99, 200000
    s_cbranch_scc1 L_sequential_preLN__linear_attn_block__dense_activation_gelu__prompt_kernel_4_x
    s_cmp_eq_u64 vcc, -1
    s_cbranch_scc0 L_sequential_preLN__linear_attn_block__dense_activation_gelu__prompt_kernel_4
L_sequential_preLN__linear_attn_block__dense_activation_gelu__prompt_kernel_4_x:
    v_mov_b32 v112, 163772
    v_mov_b32 v113, 1
    s_mov_b64 exec, 1
    ds_add_u32 v112, v113
    s_mov_b64 exec, -1
    s_getreg_b32 s88, hwreg(HW_REG_XCC_ID, 0, 4)
    s_or_b32 s88, s88, 0x80
    v_mov_b32 v126, s88
    v_mov_b32 v127, 0
    s_lshl_b32 s89, s65, 5
    s_lshl_b32 s88, s64, 10
    s_add_u32 s89, s89, s88
    s_add_u32 s89, s89, 102400
    s_cmp_eq_u32 s66, 0
    s_cselect_b32 s89, s89, 2130706432
    s_mov_b64 exec, 1
    buffer_store_dword v126, v127, s[44:47], s89 offen sc1
    s_mov_b64 exec, -1
    v_mov_b32 v112, 163772
    ds_read_b32 v113, v112
    s_waitcnt lgkmcnt(0)
    v_readfirstlane_b32 s98, v113
    s_nop 0
    s_cmp_lt_u32 s98, 4
    s_cbranch_scc1 L_sequential_preLN__linear_attn_block__dense_activation_gelu__prompt_kernel_5
    v_mov_b32 v112, 163772
    s_mov_b32 s99, 0
    s_branch L_sequential_preLN__linear_attn_block__dense_activation_gelu__prompt_kernel_6_f
L_sequential_preLN__linear_attn_block__dense_activation_gelu__prompt_kernel_6:
    s_sleep 1
L_sequential_preLN__linear_attn_block__dense_activation_gelu__prompt_kernel_6_f:
    ds_read_b32 v113, v112
    s_add_u32 s99, s99, 1
    s_waitcnt lgkmcnt(0)
    v_readfirstlane_b32 s98, v113
    s_cmp_gt_u32 s99, 800000
    s_cbranch_scc1 L_sequential_preLN__linear_attn_block__dense_activation_gelu__prompt_kernel_6_x
    s_cmp_lt_u32 s98, 4
    s_cbranch_scc1 L_sequential_preLN__linear_attn_block__dense_activation_gelu__prompt_kernel_6
L_sequential_preLN__linear_attn_block__dense_activation_gelu__prompt_kernel_6_x:
    v_lshrrev_b32 v112, 4, v1
    v_xor_b32 v112, v112, v1
    v_and_b32 v112, 1, v112
    v_cmp_eq_u32 vcc, 0, v112
    v_mov_b32 v112, 0x3f803f80
    s_nop 0
    v_cndmask_b32 v104, 0, v112, vcc
    v_cndmask_b32 v105, 0, v112, vcc
    v_cndmask_b32 v106, 0, v112, vcc
    v_cndmask_b32 v107, 0, v112, vcc
    ds_read_b64_tr_b16 v[48:49], v125 offset:0
    ds_read_b64_tr_b16 v[50:51], v125 offset:256
    ds_read_b64_tr_b16 v[52:53], v125 offset:1024
    ds_read_b64_tr_b16 v[54:55], v125 offset:1280
    ds_read_b64_tr_b16 v[56:57], v125 offset:2048
    ds_read_b64_tr_b16 v[58:59], v125 offset:2304
    ds_read_b64_tr_b16 v[60:61], v125 offset:3072
    ds_read_b64_tr_b16 v[62:63], v125 offset:3328
    s_waitcnt lgkmcnt(6)
    v_mfma_f32_16x16x32_bf16 v[108:111], v[104:107], v[48:51], 0
    ds_read_b64_tr_b16 v[64:65], v125 offset:4096
    ds_read_b64_tr_b16 v[66:67], v125 offset:4352
    s_waitcnt lgkmcnt(6)
    v_mfma_f32_16x16x32_bf16 v[108:111], v[104:107], v[52:55], v[108:111]
    ds_read_b64_tr_b16 v[68:69], v125 offset:5120
    ds_read_b64_tr_b16 v[70:71], v125 offset:5376
    s_waitcnt lgkmcnt(6)
    v_mfma_f32_16x16x32_bf16 v[108:111], v[104:107], v[56:59], v[108:111]
    ds_read_b64_tr_b16 v[72:73], v125 offset:6144
    ds_read_b64_tr_b16 v[74:75], v125 offset:6400
    s_waitcnt lgkmcnt(6)
    v_mfma_f32_16x16x32_bf16 v[108:111], v[104:107], v[60:63], v[108:111]
    ds_read_b64_tr_b16 v[76:77], v125 offset:7168
    ds_read_b64_tr_b16 v[78:79], v125 offset:7424
    s_waitcnt lgkmcnt(6)
    v_mfma_f32_16x16x32_bf16 v[108:111], v[104:107], v[64:67], v[108:111]
    ds_read_b64_tr_b16 v[80:81], v125 offset:8192
    ds_read_b64_tr_b16 v[82:83], v125 offset:8448
    s_waitcnt lgkmcnt(6)
    v_mfma_f32_16x16x32_bf16 v[108:111], v[104:107], v[68:71], v[108:111]
    ds_read_b64_tr_b16 v[84:85], v125 offset:9216
    ds_read_b64_tr_b16 v[86:87], v125 offset:9472
    s_waitcnt lgkmcnt(6)
    v_mfma_f32_16x16x32_bf16 v[108:111], v[104:107], v[72:75], v[108:111]
    ds_read_b64_tr_b16 v[88:89], v125 offset:10240
    ds_read_b64_tr_b16 v[90:91], v125 offset:10496
    s_waitcnt lgkmcnt(6)
    v_mfma_f32_16x16x32_bf16 v[108:111], v[104:107], v[76:79], v[108:111]
    ds_read_b64_tr_b16 v[92:93], v125 offset:11264
    ds_read_b64_tr_b16 v[94:95], v125 offset:11520
    s_waitcnt lgkmcnt(6)
    v_mfma_f32_16x16x32_bf16 v[108:111], v[104:107], v[80:83], v[108:111]
    ds_read_b64_tr_b16 v[96:97], v125 offset:12288
    ds_read_b64_tr_b16 v[98:99], v125 offset:12544
    s_waitcnt lgkmcnt(6)
    v_mfma_f32_16x16x32_bf16 v[108:111], v[104:107], v[84:87], v[108:111]
    ds_read_b64_tr_b16 v[100:101], v125 offset:13312
    ds_read_b64_tr_b16 v[102:103], v125 offset:13568
    s_waitcnt lgkmcnt(6)
    v_mfma_f32_16x16x32_bf16 v[108:111], v[104:107], v[88:91], v[108:111]
    s_waitcnt lgkmcnt(4)
    v_mfma_f32_16x16x32_bf16 v[108:111], v[104:107], v[92:95], v[108:111]
    s_waitcnt lgkmcnt(2)
    v_mfma_f32_16x16x32_bf16 v[108:111], v[104:107], v[96:99], v[108:111]
    s_waitcnt lgkmcnt(0)
    v_mfma_f32_16x16x32_bf16 v[108:111], v[104:107], v[100:103], v[108:111]
    v_bfe_u32 v112, v1, 4, 1
    v_cmp_eq_u32 vcc, 1, v112
    v_and_b32 v113, 31, v1
    v_lshlrev_b32 v113, 2, v113
    s_lshl_b32 s88, s66, 7
    s_add_u32 s88, s88, 157696
    v_add_u32 v113, s88, v113
    s_nop 0
    v_cndmask_b32 v108, v108, v109, vcc
    ds_write_b32 v113, v108
    s_waitcnt lgkmcnt(0)
    v_mov_b32 v112, 163776
    v_mov_b32 v113, 1
    s_mov_b64 exec, 1
    ds_add_u32 v112, v113
    s_mov_b64 exec, -1
    v_mov_b32 v112, 163768
    s_mov_b32 s99, 0
    s_branch L_sequential_preLN__linear_attn_block__dense_activation_gelu__prompt_kernel_7_f
L_sequential_preLN__linear_attn_block__dense_activation_gelu__prompt_kernel_7:
    s_sleep 1
L_sequential_preLN__linear_attn_block__dense_activation_gelu__prompt_kernel_7_f:
    ds_read_b32 v113, v112
    s_add_u32 s99, s99, 1
    s_waitcnt lgkmcnt(0)
    v_readfirstlane_b32 s98, v113
    s_cmp_gt_u32 s99, 800000
    s_cbranch_scc1 L_sequential_preLN__linear_attn_block__dense_activation_gelu__prompt_kernel_7_x
    s_cmp_lt_u32 s98, 4
    s_cbranch_scc1 L_sequential_preLN__linear_attn_block__dense_activation_gelu__prompt_kernel_7
L_sequential_preLN__linear_attn_block__dense_activation_gelu__prompt_kernel_7_x:
    ds_read_b32 v16, v12 offset:0
    ds_read_b32 v17, v12 offset:20480
    ds_read_b32 v18, v12 offset:24576
    ds_read_b32 v19, v12 offset:45056
    ds_read_b32 v20, v12 offset:256
    ds_read_b32 v21, v12 offset:20736
    ds_read_b32 v22, v12 offset:24832
    ds_read_b32 v23, v12 offset:45312
    ds_read_b32 v24, v12 offset:512
    ds_read_b32 v25, v12 offset:20992
    ds_read_b32 v26, v12 offset:25088
    ds_read_b32 v27, v12 offset:45568
    s_waitcnt lgkmcnt(8)
    v_add_f32 v16, v16, v17
    v_add_f32 v18, v18, v19
    v_add_f32 v16, v16, v18
    buffer_atomic_add_f32 v16, v11, s[44:47], s78 offen offset:0
    ds_read_b32 v28, v12 offset:768
    ds_read_b32 v29, v12 offset:21248
    ds_read_b32 v30, v12 offset:25344
    ds_read_b32 v31, v12 offset:45824
    s_waitcnt lgkmcnt(8)
    v_add_f32 v20, v20, v21
    v_add_f32 v22, v22, v23
    v_add_f32 v20, v20, v22
    buffer_atomic_add_f32 v20, v11, s[44:47], s78 offen offset:256
    ds_read_b32 v32, v12 offset:1024
    ds_read_b32 v33, v12 offset:21504
    ds_read_b32 v34, v12 offset:25600
    ds_read_b32 v35, v12 offset:46080
    s_waitcnt lgkmcnt(8)
    v_add_f32 v24, v24, v25
    v_add_f32 v26, v26, v27
    v_add_f32 v24, v24, v26
    buffer_atomic_add_f32 v24, v11, s[44:47], s78 offen offset:512
    ds_read_b32 v36, v12 offset:1280
    ds_read_b32 v37, v12 offset:21760
    ds_read_b32 v38, v12 offset:25856
    ds_read_b32 v39, v12 offset:46336
    s_waitcnt lgkmcnt(8)
    v_add_f32 v28, v28, v29
    v_add_f32 v30, v30, v31
    v_add_f32 v28, v28, v30
    buffer_atomic_add_f32 v28, v11, s[44:47], s78 offen offset:768
    ds_read_b32 v40, v12 offset:1536
    ds_read_b32 v41, v12 offset:22016
    ds_read_b32 v42, v12 offset:26112
    ds_read_b32 v43, v12 offset:46592
    s_waitcnt lgkmcnt(8)
    v_add_f32 v32, v32, v33
    v_add_f32 v34, v34, v35
    v_add_f32 v32, v32, v34
    buffer_atomic_add_f32 v32, v11, s[44:47], s78 offen offset:1024
    ds_read_b32 v44, v12 offset:1792
    ds_read_b32 v45, v12 offset:22272
    ds_read_b32 v46, v12 offset:26368
    ds_read_b32 v47, v12 offset:46848
    s_waitcnt lgkmcnt(8)
    v_add_f32 v36, v36, v37
    v_add_f32 v38, v38, v39
    v_add_f32 v36, v36, v38
    buffer_atomic_add_f32 v36, v11, s[44:47], s78 offen offset:1280
    s_waitcnt lgkmcnt(4)
    v_add_f32 v40, v40, v41
    v_add_f32 v42, v42, v43
    v_add_f32 v40, v40, v42
    buffer_atomic_add_f32 v40, v11, s[44:47], s78 offen offset:1536
    s_waitcnt lgkmcnt(0)
    v_add_f32 v44, v44, v45
    v_add_f32 v46, v46, v47
    v_add_f32 v44, v44, v46
    buffer_atomic_add_f32 v44, v11, s[44:47], s78 offen offset:1792
    s_branch L_sequential_preLN__linear_attn_block__dense_activation_gelu__prompt_kernel_5_e
L_sequential_preLN__linear_attn_block__dense_activation_gelu__prompt_kernel_5:
    v_mov_b32 v112, 163768
    s_mov_b32 s99, 0
    s_branch L_sequential_preLN__linear_attn_block__dense_activation_gelu__prompt_kernel_8_f
L_sequential_preLN__linear_attn_block__dense_activation_gelu__prompt_kernel_8:
    s_sleep 1
L_sequential_preLN__linear_attn_block__dense_activation_gelu__prompt_kernel_8_f:
    ds_read_b32 v113, v112
    s_add_u32 s99, s99, 1
    s_waitcnt lgkmcnt(0)
    v_readfirstlane_b32 s98, v113
    s_cmp_gt_u32 s99, 800000
    s_cbranch_scc1 L_sequential_preLN__linear_attn_block__dense_activation_gelu__prompt_kernel_8_x
    s_cmp_lt_u32 s98, 4
    s_cbranch_scc1 L_sequential_preLN__linear_attn_block__dense_activation_gelu__prompt_kernel_8
L_sequential_preLN__linear_attn_block__dense_activation_gelu__prompt_kernel_8_x:
    ds_read_b32 v16, v12 offset:0
    ds_read_b32 v17, v12 offset:20480
    ds_read_b32 v18, v12 offset:24576
    ds_read_b32 v19, v12 offset:45056
    ds_read_b32 v20, v12 offset:256
    ds_read_b32 v21, v12 offset:20736
    ds_read_b32 v22, v12 offset:24832
    ds_read_b32 v23, v12 offset:45312
    ds_read_b32 v24, v12 offset:512
    ds_read_b32 v25, v12 offset:20992
    ds_read_b32 v26, v12 offset:25088
    ds_read_b32 v27, v12 offset:45568
    s_waitcnt lgkmcnt(8)
    v_add_f32 v16, v16, v17
    v_add_f32 v18, v18, v19
    v_add_f32 v16, v16, v18
    buffer_atomic_add_f32 v16, v11, s[44:47], s78 offen offset:0
    ds_read_b32 v28, v12 offset:768
    ds_read_b32 v29, v12 offset:21248
    ds_read_b32 v30, v12 offset:25344
    ds_read_b32 v31, v12 offset:45824
    s_waitcnt lgkmcnt(8)
    v_add_f32 v20, v20, v21
    v_add_f32 v22, v22, v23
    v_add_f32 v20, v20, v22
    buffer_atomic_add_f32 v20, v11, s[44:47], s78 offen offset:256
    ds_read_b32 v32, v12 offset:1024
    ds_read_b32 v33, v12 offset:21504
    ds_read_b32 v34, v12 offset:25600
    ds_read_b32 v35, v12 offset:46080
    s_waitcnt lgkmcnt(8)
    v_add_f32 v24, v24, v25
    v_add_f32 v26, v26, v27
    v_add_f32 v24, v24, v26
    buffer_atomic_add_f32 v24, v11, s[44:47], s78 offen offset:512
    ds_read_b32 v36, v12 offset:1280
    ds_read_b32 v37, v12 offset:21760
    ds_read_b32 v38, v12 offset:25856
    ds_read_b32 v39, v12 offset:46336
    s_waitcnt lgkmcnt(8)
    v_add_f32 v28, v28, v29
    v_add_f32 v30, v30, v31
    v_add_f32 v28, v28, v30
    buffer_atomic_add_f32 v28, v11, s[44:47], s78 offen offset:768
    ds_read_b32 v40, v12 offset:1536
    ds_read_b32 v41, v12 offset:22016
    ds_read_b32 v42, v12 offset:26112
    ds_read_b32 v43, v12 offset:46592
    s_waitcnt lgkmcnt(8)
    v_add_f32 v32, v32, v33
    v_add_f32 v34, v34, v35
    v_add_f32 v32, v32, v34
    buffer_atomic_add_f32 v32, v11, s[44:47], s78 offen offset:1024
    ds_read_b32 v44, v12 offset:1792
    ds_read_b32 v45, v12 offset:22272
    ds_read_b32 v46, v12 offset:26368
    ds_read_b32 v47, v12 offset:46848
    s_waitcnt lgkmcnt(8)
    v_add_f32 v36, v36, v37
    v_add_f32 v38, v38, v39
    v_add_f32 v36, v36, v38
    buffer_atomic_add_f32 v36, v11, s[44:47], s78 offen offset:1280
    s_waitcnt lgkmcnt(4)
    v_add_f32 v40, v40, v41
    v_add_f32 v42, v42, v43
    v_add_f32 v40, v40, v42
    buffer_atomic_add_f32 v40, v11, s[44:47], s78 offen offset:1536
    s_waitcnt lgkmcnt(0)
    v_add_f32 v44, v44, v45
    v_add_f32 v46, v46, v47
    v_add_f32 v44, v44, v46
    buffer_atomic_add_f32 v44, v11, s[44:47], s78 offen offset:1792
    v_mov_b32 v112, 163772
    s_mov_b32 s99, 0
    s_branch L_sequential_preLN__linear_attn_block__dense_activation_gelu__prompt_kernel_9_f
L_sequential_preLN__linear_attn_block__dense_activation_gelu__prompt_kernel_9:
    s_sleep 1
L_sequential_preLN__linear_attn_block__dense_activation_gelu__prompt_kernel_9_f:
    ds_read_b32 v113, v112
    s_add_u32 s99, s99, 1
    s_waitcnt lgkmcnt(0)
    v_readfirstlane_b32 s98, v113
    s_cmp_gt_u32 s99, 800000
    s_cbranch_scc1 L_sequential_preLN__linear_attn_block__dense_activation_gelu__prompt_kernel_9_x
    s_cmp_lt_u32 s98, 4
    s_cbranch_scc1 L_sequential_preLN__linear_attn_block__dense_activation_gelu__prompt_kernel_9
L_sequential_preLN__linear_attn_block__dense_activation_gelu__prompt_kernel_9_x:
    v_lshrrev_b32 v112, 4, v1
    v_xor_b32 v112, v112, v1
    v_and_b32 v112, 1, v112
    v_cmp_eq_u32 vcc, 0, v112
    v_mov_b32 v112, 0x3f803f80
    s_nop 0
    v_cndmask_b32 v104, 0, v112, vcc
    v_cndmask_b32 v105, 0, v112, vcc
    v_cndmask_b32 v106, 0, v112, vcc
    v_cndmask_b32 v107, 0, v112, vcc
    ds_read_b64_tr_b16 v[48:49], v125 offset:0
    ds_read_b64_tr_b16 v[50:51], v125 offset:256
    ds_read_b64_tr_b16 v[52:53], v125 offset:1024
    ds_read_b64_tr_b16 v[54:55], v125 offset:1280
    ds_read_b64_tr_b16 v[56:57], v125 offset:2048
    ds_read_b64_tr_b16 v[58:59], v125 offset:2304
    ds_read_b64_tr_b16 v[60:61], v125 offset:3072
    ds_read_b64_tr_b16 v[62:63], v125 offset:3328
    s_waitcnt lgkmcnt(6)
    v_mfma_f32_16x16x32_bf16 v[108:111], v[104:107], v[48:51], 0
    ds_read_b64_tr_b16 v[64:65], v125 offset:4096
    ds_read_b64_tr_b16 v[66:67], v125 offset:4352
    s_waitcnt lgkmcnt(6)
    v_mfma_f32_16x16x32_bf16 v[108:111], v[104:107], v[52:55], v[108:111]
    ds_read_b64_tr_b16 v[68:69], v125 offset:5120
    ds_read_b64_tr_b16 v[70:71], v125 offset:5376
    s_waitcnt lgkmcnt(6)
    v_mfma_f32_16x16x32_bf16 v[108:111], v[104:107], v[56:59], v[108:111]
    ds_read_b64_tr_b16 v[72:73], v125 offset:6144
    ds_read_b64_tr_b16 v[74:75], v125 offset:6400
    s_waitcnt lgkmcnt(6)
    v_mfma_f32_16x16x32_bf16 v[108:111], v[104:107], v[60:63], v[108:111]
    ds_read_b64_tr_b16 v[76:77], v125 offset:7168
    ds_read_b64_tr_b16 v[78:79], v125 offset:7424
    s_waitcnt lgkmcnt(6)
    v_mfma_f32_16x16x32_bf16 v[108:111], v[104:107], v[64:67], v[108:111]
    ds_read_b64_tr_b16 v[80:81], v125 offset:8192
    ds_read_b64_tr_b16 v[82:83], v125 offset:8448
    s_waitcnt lgkmcnt(6)
    v_mfma_f32_16x16x32_bf16 v[108:111], v[104:107], v[68:71], v[108:111]
    ds_read_b64_tr_b16 v[84:85], v125 offset:9216
    ds_read_b64_tr_b16 v[86:87], v125 offset:9472
    s_waitcnt lgkmcnt(6)
    v_mfma_f32_16x16x32_bf16 v[108:111], v[104:107], v[72:75], v[108:111]
    ds_read_b64_tr_b16 v[88:89], v125 offset:10240
    ds_read_b64_tr_b16 v[90:91], v125 offset:10496
    s_waitcnt lgkmcnt(6)
    v_mfma_f32_16x16x32_bf16 v[108:111], v[104:107], v[76:79], v[108:111]
    ds_read_b64_tr_b16 v[92:93], v125 offset:11264
    ds_read_b64_tr_b16 v[94:95], v125 offset:11520
    s_waitcnt lgkmcnt(6)
    v_mfma_f32_16x16x32_bf16 v[108:111], v[104:107], v[80:83], v[108:111]
    ds_read_b64_tr_b16 v[96:97], v125 offset:12288
    ds_read_b64_tr_b16 v[98:99], v125 offset:12544
    s_waitcnt lgkmcnt(6)
    v_mfma_f32_16x16x32_bf16 v[108:111], v[104:107], v[84:87], v[108:111]
    ds_read_b64_tr_b16 v[100:101], v125 offset:13312
    ds_read_b64_tr_b16 v[102:103], v125 offset:13568
    s_waitcnt lgkmcnt(6)
    v_mfma_f32_16x16x32_bf16 v[108:111], v[104:107], v[88:91], v[108:111]
    s_waitcnt lgkmcnt(4)
    v_mfma_f32_16x16x32_bf16 v[108:111], v[104:107], v[92:95], v[108:111]
    s_waitcnt lgkmcnt(2)
    v_mfma_f32_16x16x32_bf16 v[108:111], v[104:107], v[96:99], v[108:111]
    s_waitcnt lgkmcnt(0)
    v_mfma_f32_16x16x32_bf16 v[108:111], v[104:107], v[100:103], v[108:111]
    v_bfe_u32 v112, v1, 4, 1
    v_cmp_eq_u32 vcc, 1, v112
    v_and_b32 v113, 31, v1
    v_lshlrev_b32 v113, 2, v113
    s_lshl_b32 s88, s66, 7
    s_add_u32 s88, s88, 157696
    v_add_u32 v113, s88, v113
    s_nop 0
    v_cndmask_b32 v108, v108, v109, vcc
    ds_write_b32 v113, v108
    s_waitcnt lgkmcnt(0)
    v_mov_b32 v112, 163776
    v_mov_b32 v113, 1
    s_mov_b64 exec, 1
    ds_add_u32 v112, v113
    s_mov_b64 exec, -1
L_sequential_preLN__linear_attn_block__dense_activation_gelu__prompt_kernel_5_e:
    s_lshl_b32 s88, s65, 4
    s_lshl_b32 s89, s66, 2
    s_add_u32 s88, s88, s89
    s_add_u32 s88, s88, s67
    v_mov_b32 v112, 0
    v_mov_b32 v113, 1
    s_waitcnt vmcnt(0)
    s_mov_b64 exec, 1
    buffer_store_dword v113, v112, s[4:7], s88 offen offset:0
    s_mov_b64 exec, -1
    s_branch L_sequential_preLN__linear_attn_block__dense_activation_gelu__prompt_kernel_3_e
L_sequential_preLN__linear_attn_block__dense_activation_gelu__prompt_kernel_3:
    s_add_u32 m0, s56, 0
    s_nop 0
    buffer_load_dwordx4 v96, s[16:19], s55 offen  lds
    s_add_u32 m0, s56, 2048
    s_nop 0
    buffer_load_dwordx4 v97, s[16:19], s55 offen  lds
    s_add_u32 m0, s56, 4096
    s_nop 0
    buffer_load_dwordx4 v98, s[16:19], s55 offen  lds
    s_waitcnt vmcnt(3)
    v_mov_b32 v112, 163772
    v_mov_b32 v113, 1
    s_mov_b64 exec, 1
    ds_add_u32 v112, v113
    s_mov_b64 exec, -1
    s_add_u32 m0, s56, 6144
    s_nop 0
    buffer_load_dwordx4 v99, s[16:19], s55 offen  lds
    s_add_u32 m0, s56, 8192
    s_nop 0
    buffer_load_dwordx4 v100, s[16:19], s55 offen  lds
    s_add_u32 m0, s56, 10240
    s_nop 0
    buffer_load_dwordx4 v101, s[16:19], s55 offen  lds
    s_add_u32 m0, s56, 12288
    s_nop 0
    buffer_load_dwordx4 v102, s[16:19], s55 offen  lds
    s_add_u32 m0, s56, 14336
    s_add_u32 s88, s55, 57344
    buffer_load_dwordx4 v96, s[16:19], s88 offen  lds
    s_add_u32 m0, s56, 16384
    s_add_u32 s88, s55, 57344
    buffer_load_dwordx4 v97, s[16:19], s88 offen  lds
    s_add_u32 m0, s56, 18432
    s_add_u32 s88, s55, 57344
    buffer_load_dwordx4 v98, s[16:19], s88 offen  lds
    s_add_u32 m0, s56, 20480
    s_add_u32 s88, s55, 57344
    buffer_load_dwordx4 v99, s[16:19], s88 offen  lds
    s_add_u32 m0, s56, 22528
    s_add_u32 s88, s55, 57344
    buffer_load_dwordx4 v100, s[16:19], s88 offen  lds
    s_add_u32 m0, s56, 24576
    s_add_u32 s88, s55, 57344
    buffer_load_dwordx4 v101, s[16:19], s88 offen  lds
    s_add_u32 m0, s56, 26624
    s_add_u32 s88, s55, 57344
    buffer_load_dwordx4 v102, s[16:19], s88 offen  lds
    s_add_u32 m0, s56, 28672
    s_add_u32 s88, s55, 114688
    buffer_load_dwordx4 v96, s[16:19], s88 offen  lds
    s_add_u32 m0, s56, 30720
    s_add_u32 s88, s55, 114688
    buffer_load_dwordx4 v97, s[16:19], s88 offen  lds
    s_add_u32 m0, s56, 32768
    s_add_u32 s88, s55, 114688
    buffer_load_dwordx4 v98, s[16:19], s88 offen  lds
    s_add_u32 m0, s56, 34816
    s_add_u32 s88, s55, 114688
    buffer_load_dwordx4 v99, s[16:19], s88 offen  lds
    s_add_u32 m0, s56, 36864
    s_add_u32 s88, s55, 114688
    buffer_load_dwordx4 v100, s[16:19], s88 offen  lds
    s_add_u32 m0, s56, 38912
    s_add_u32 s88, s55, 114688
    buffer_load_dwordx4 v101, s[16:19], s88 offen  lds
    s_add_u32 m0, s56, 40960
    s_add_u32 s88, s55, 114688
    buffer_load_dwordx4 v102, s[16:19], s88 offen  lds
    s_add_u32 m0, s56, 43008
    s_add_u32 s88, s55, 172032
    buffer_load_dwordx4 v96, s[16:19], s88 offen  lds
    s_add_u32 m0, s56, 45056
    s_add_u32 s88, s55, 172032
    buffer_load_dwordx4 v97, s[16:19], s88 offen  lds
    s_add_u32 m0, s56, 47104
    s_add_u32 s88, s55, 172032
    buffer_load_dwordx4 v98, s[16:19], s88 offen  lds
    s_add_u32 m0, s56, 49152
    s_add_u32 s88, s55, 172032
    buffer_load_dwordx4 v99, s[16:19], s88 offen  lds
    s_add_u32 m0, s56, 51200
    s_add_u32 s88, s55, 172032
    buffer_load_dwordx4 v100, s[16:19], s88 offen  lds
    s_add_u32 m0, s56, 53248
    s_add_u32 s88, s55, 172032
    buffer_load_dwordx4 v101, s[16:19], s88 offen  lds
    s_add_u32 m0, s56, 55296
    s_add_u32 s88, s55, 172032
    buffer_load_dwordx4 v102, s[16:19], s88 offen  lds
    s_add_u32 m0, s56, 57344
    s_add_u32 s88, s55, 229376
    buffer_load_dwordx4 v96, s[16:19], s88 offen  lds
    s_add_u32 m0, s56, 59392
    s_add_u32 s88, s55, 229376
    buffer_load_dwordx4 v97, s[16:19], s88 offen  lds
    s_add_u32 m0, s56, 61440
    s_add_u32 s88, s55, 229376
    buffer_load_dwordx4 v98, s[16:19], s88 offen  lds
    s_add_u32 m0, s56, 63488
    s_add_u32 s88, s55, 229376
    buffer_load_dwordx4 v99, s[16:19], s88 offen  lds
    s_add_u32 m0, s56, 65536
    s_add_u32 s88, s55, 229376
    buffer_load_dwordx4 v100, s[16:19], s88 offen  lds
    s_add_u32 m0, s56, 67584
    s_add_u32 s88, s55, 229376
    buffer_load_dwordx4 v101, s[16:19], s88 offen  lds
    s_add_u32 m0, s56, 69632
    s_add_u32 s88, s55, 229376
    buffer_load_dwordx4 v102, s[16:19], s88 offen  lds
    s_add_u32 m0, s56, 71680
    s_add_u32 s88, s55, 286720
    buffer_load_dwordx4 v96, s[16:19], s88 offen  lds
    s_add_u32 m0, s56, 73728
    s_add_u32 s88, s55, 286720
    buffer_load_dwordx4 v97, s[16:19], s88 offen  lds
    s_add_u32 m0, s56, 75776
    s_add_u32 s88, s55, 286720
    buffer_load_dwordx4 v98, s[16:19], s88 offen  lds
    s_add_u32 m0, s56, 77824
    s_add_u32 s88, s55, 286720
    buffer_load_dwordx4 v99, s[16:19], s88 offen  lds
    s_add_u32 m0, s56, 79872
    s_add_u32 s88, s55, 286720
    buffer_load_dwordx4 v100, s[16:19], s88 offen  lds
    s_add_u32 m0, s56, 81920
    s_add_u32 s88, s55, 286720
    buffer_load_dwordx4 v101, s[16:19], s88 offen  lds
    s_add_u32 m0, s56, 83968
    s_add_u32 s88, s55, 286720
    buffer_load_dwordx4 v102, s[16:19], s88 offen  lds
    s_add_u32 m0, s56, 86016
    s_add_u32 s88, s55, 344064
    buffer_load_dwordx4 v96, s[16:19], s88 offen  lds
    s_add_u32 m0, s56, 88064
    s_add_u32 s88, s55, 344064
    buffer_load_dwordx4 v97, s[16:19], s88 offen  lds
    s_add_u32 m0, s56, 90112
    s_add_u32 s88, s55, 344064
    buffer_load_dwordx4 v98, s[16:19], s88 offen  lds
    s_add_u32 m0, s56, 92160
    s_add_u32 s88, s55, 344064
    buffer_load_dwordx4 v99, s[16:19], s88 offen  lds
    s_add_u32 m0, s56, 94208
    s_add_u32 s88, s55, 344064
    buffer_load_dwordx4 v100, s[16:19], s88 offen  lds
    s_add_u32 m0, s56, 96256
    s_add_u32 s88, s55, 344064
    buffer_load_dwordx4 v101, s[16:19], s88 offen  lds
    s_add_u32 m0, s56, 98304
    s_add_u32 s88, s55, 344064
    buffer_load_dwordx4 v102, s[16:19], s88 offen  lds
    s_add_u32 m0, s56, 100352
    s_add_u32 s88, s55, 401408
    buffer_load_dwordx4 v96, s[16:19], s88 offen  lds
L_sequential_preLN__linear_attn_block__dense_activation_gelu__prompt_kernel_3_e:
    s_lshl_b32 s88, s65, 2
    s_add_u32 s88, s88, s66
    s_cmp_lg_u32 s88, 120
    s_cbranch_scc1 L_sequential_preLN__linear_attn_block__dense_activation_gelu__prompt_kernel_10
    s_mov_b32 s99, 0
    s_branch L_sequential_preLN__linear_attn_block__dense_activation_gelu__prompt_kernel_11_f
L_sequential_preLN__linear_attn_block__dense_activation_gelu__prompt_kernel_11:
    s_sleep 1
L_sequential_preLN__linear_attn_block__dense_activation_gelu__prompt_kernel_11_f:
    buffer_load_dwordx2 v[112:113], v4, s[44:47], s67 offen offset:0 sc1
    s_waitcnt vmcnt(0)
L_sequential_preLN__linear_attn_block__dense_activation_gelu__prompt_kernel_11_c:
    s_add_u32 s99, s99, 1
    v_and_b32 v112, v112, v113
    v_cmp_ne_u32 vcc, 0, v112
    s_nop 0
    s_andn2_b64 s[94:95], s[96:97], vcc
    s_cmp_eq_u64 s[94:95], 0
    s_cbranch_scc1 L_sequential_preLN__linear_attn_block__dense_activation_gelu__prompt_kernel_11_x
    s_cmp_lt_u32 s99, 32
    s_cbranch_scc1 L_sequential_preLN__linear_attn_block__dense_activation_gelu__prompt_kernel_11
    s_lshl_b32 s88, s65, 4
    s_lshl_b32 s89, s66, 2
    s_add_u32 s88, s88, s89
    s_add_u32 s88, s88, s67
    v_mov_b32 v112, 0
    v_mov_b32 v113, 1
    s_mov_b64 exec, 1
    buffer_store_dword v113, v112, s[44:47], s88 offen offset:2048 sc1
    s_mov_b64 exec, -1
L_sequential_preLN__linear_attn_block__dense_activation_gelu__prompt_kernel_11_s:
    buffer_load_dwordx2 v[112:113], v4, s[44:47], s67 offen offset:0 sc1
    buffer_load_dwordx2 v[114:115], v4, s[44:47], s67 offen offset:2048 sc1
    s_add_u32 s99, s99, 1
    s_waitcnt vmcnt(0)
    v_or_b32 v112, v112, v114
    v_or_b32 v113, v113, v115
    v_and_b32 v112, v112, v113
    v_cmp_ne_u32 vcc, 0, v112
    s_nop 0
    s_andn2_b64 s[94:95], s[96:97], vcc
    s_cmp_eq_u64 s[94:95], 0
    s_cbranch_scc1 L_sequential_preLN__linear_attn_block__dense_activation_gelu__prompt_kernel_11_x
    s_cmp_lt_u32 s99, 200000
    s_cbranch_scc1 L_sequential_preLN__linear_attn_block__dense_activation_gelu__prompt_kernel_11_s
L_sequential_preLN__linear_attn_block__dense_activation_gelu__prompt_kernel_11_x:
    v_mov_b32 v112, 0
    v_mov_b32 v113, 1
    s_lshl_b32 s88, s64, 7
    s_add_u32 s88, s88, s91
    s_mov_b64 exec, 1
    buffer_store_dword v113, v112, s[44:47], s88 offen sc1
    s_mov_b64 exec, -1
L_sequential_preLN__linear_attn_block__dense_activation_gelu__prompt_kernel_10:
    s_waitcnt vmcnt(0)
    v_mov_b32 v112, 163744
    v_mov_b32 v113, 1
    s_mov_b64 exec, 1
    ds_add_u32 v112, v113
    s_mov_b64 exec, -1
    v_mov_b32 v112, 163744
    s_mov_b32 s99, 0
    s_branch L_sequential_preLN__linear_attn_block__dense_activation_gelu__prompt_kernel_12_f
L_sequential_preLN__linear_attn_block__dense_activation_gelu__prompt_kernel_12:
    s_cmp_lg_u32 s99, 100
    s_cbranch_scc1 L_sequential_preLN__linear_attn_block__dense_activation_gelu__prompt_kernel_12_p
    s_lshl_b32 s88, s65, 4
    s_lshl_b32 s89, s66, 2
    s_add_u32 s88, s88, s89
    s_add_u32 s88, s88, s67
    v_mov_b32 v113, 0
    v_mov_b32 v114, 1
    s_mov_b64 exec, 1
    buffer_store_dword v114, v113, s[44:47], s88 offen offset:2048 sc1
    s_mov_b64 exec, -1
L_sequential_preLN__linear_attn_block__dense_activation_gelu__prompt_kernel_12_p:
    s_sleep 1
L_sequential_preLN__linear_attn_block__dense_activation_gelu__prompt_kernel_12_f:
    ds_read_b32 v113, v112
    s_add_u32 s99, s99, 1
    s_waitcnt lgkmcnt(0)
    v_readfirstlane_b32 s98, v113
    s_cmp_gt_u32 s99, 800000
    s_cbranch_scc1 L_sequential_preLN__linear_attn_block__dense_activation_gelu__prompt_kernel_12_x
    s_cmp_lt_u32 s98, 4
    s_cbranch_scc1 L_sequential_preLN__linear_attn_block__dense_activation_gelu__prompt_kernel_12
L_sequential_preLN__linear_attn_block__dense_activation_gelu__prompt_kernel_12_x:
    ds_read_b64_tr_b16 a[0:1], v9 offset:0
    ds_read_b64_tr_b16 a[2:3], v9 offset:3584
    ds_read_b64_tr_b16 a[4:5], v9 offset:32
    ds_read_b64_tr_b16 a[6:7], v9 offset:3616
    ds_read_b64_tr_b16 a[8:9], v9 offset:6272
    ds_read_b64_tr_b16 a[10:11], v9 offset:9856
    ds_read_b64_tr_b16 a[12:13], v9 offset:6304
    ds_read_b64_tr_b16 a[14:15], v9 offset:9888
    ds_read_b64_tr_b16 a[16:17], v9 offset:12544
    ds_read_b64_tr_b16 a[18:19], v9 offset:16128
    ds_read_b64_tr_b16 a[20:21], v9 offset:12576
    ds_read_b64_tr_b16 a[22:23], v9 offset:16160
    ds_read_b64_tr_b16 a[24:25], v9 offset:18816
    ds_read_b64_tr_b16 a[26:27], v9 offset:22400
    ds_read_b64_tr_b16 a[28:29], v9 offset:18848
    ds_read_b64_tr_b16 a[30:31], v9 offset:22432
    ds_read_b64_tr_b16 a[32:33], v9 offset:25088
    ds_read_b64_tr_b16 a[34:35], v9 offset:28672
    ds_read_b64_tr_b16 a[36:37], v9 offset:25120
    ds_read_b64_tr_b16 a[38:39], v9 offset:28704
    ds_read_b64_tr_b16 a[40:41], v9 offset:31360
    ds_read_b64_tr_b16 a[42:43], v9 offset:34944
    ds_read_b64_tr_b16 a[44:45], v9 offset:31392
    ds_read_b64_tr_b16 a[46:47], v9 offset:34976
    ds_read_b64_tr_b16 a[48:49], v9 offset:37632
    ds_read_b64_tr_b16 a[50:51], v9 offset:41216
    ds_read_b64_tr_b16 a[52:53], v9 offset:37664
    ds_read_b64_tr_b16 a[54:55], v9 offset:41248
    ds_read_b64_tr_b16 a[56:57], v9 offset:43904
    ds_read_b64_tr_b16 a[58:59], v9 offset:47488
    ds_read_b64_tr_b16 a[60:61], v9 offset:43936
    ds_read_b64_tr_b16 a[62:63], v9 offset:47520
    ds_read_b64_tr_b16 a[64:65], v8 offset:0
    ds_read_b64_tr_b16 a[66:67], v8 offset:3584
    ds_read_b64_tr_b16 a[68:69], v8 offset:32
    ds_read_b64_tr_b16 a[70:71], v8 offset:3616
    ds_read_b64_tr_b16 a[72:73], v8 offset:6272
    ds_read_b64_tr_b16 a[74:75], v8 offset:9856
    ds_read_b64_tr_b16 a[76:77], v8 offset:6304
    ds_read_b64_tr_b16 a[78:79], v8 offset:9888
    ds_read_b64_tr_b16 a[80:81], v8 offset:12544
    ds_read_b64_tr_b16 a[82:83], v8 offset:16128
    ds_read_b64_tr_b16 a[84:85], v8 offset:12576
    ds_read_b64_tr_b16 a[86:87], v8 offset:16160
    ds_read_b64_tr_b16 a[88:89], v8 offset:18816
    ds_read_b64_tr_b16 a[90:91], v8 offset:22400
    ds_read_b64_tr_b16 a[92:93], v8 offset:18848
    ds_read_b64_tr_b16 a[94:95], v8 offset:22432
    ds_read_b64_tr_b16 a[96:97], v8 offset:25088
    ds_read_b64_tr_b16 a[98:99], v8 offset:28672
    ds_read_b64_tr_b16 a[100:101], v8 offset:25120
    ds_read_b64_tr_b16 a[102:103], v8 offset:28704
    ds_read_b64_tr_b16 a[104:105], v8 offset:31360
    ds_read_b64_tr_b16 a[106:107], v8 offset:34944
    ds_read_b64_tr_b16 a[108:109], v8 offset:31392
    ds_read_b64_tr_b16 a[110:111], v8 offset:34976
    ds_read_b64_tr_b16 a[112:113], v8 offset:37632
    ds_read_b64_tr_b16 a[114:115], v8 offset:41216
    ds_read_b64_tr_b16 a[116:117], v8 offset:37664
    ds_read_b64_tr_b16 a[118:119], v8 offset:41248
    ds_read_b64_tr_b16 a[120:121], v8 offset:43904
    ds_read_b64_tr_b16 a[122:123], v8 offset:47488
    ds_read_b64_tr_b16 a[124:125], v8 offset:43936
    ds_read_b64_tr_b16 a[126:127], v8 offset:47520
    s_waitcnt lgkmcnt(0)
    v_mov_b32 v112, 163712
    v_mov_b32 v113, 1
    s_mov_b64 exec, 1
    ds_add_u32 v112, v113
    s_mov_b64 exec, -1
    v_mov_b32 v112, 163712
    s_mov_b32 s99, 0
    s_branch L_sequential_preLN__linear_attn_block__dense_activation_gelu__prompt_kernel_13_f
L_sequential_preLN__linear_attn_block__dense_activation_gelu__prompt_kernel_13:
    s_sleep 1
L_sequential_preLN__linear_attn_block__dense_activation_gelu__prompt_kernel_13_f:
    ds_read_b32 v113, v112
    s_add_u32 s99, s99, 1
    s_waitcnt lgkmcnt(0)
    v_readfirstlane_b32 s98, v113
    s_cmp_gt_u32 s99, 800000
    s_cbranch_scc1 L_sequential_preLN__linear_attn_block__dense_activation_gelu__prompt_kernel_13_x
    s_cmp_lt_u32 s98, 4
    s_cbranch_scc1 L_sequential_preLN__linear_attn_block__dense_activation_gelu__prompt_kernel_13
L_sequential_preLN__linear_attn_block__dense_activation_gelu__prompt_kernel_13_x:
    s_cmp_lt_u32 s66, 2
    s_cbranch_scc1 L_sequential_preLN__linear_attn_block__dense_activation_gelu__prompt_kernel_14
    s_add_u32 m0, s56, 94208
    s_nop 0
    buffer_load_dwordx4 v96, s[8:11], s48 offen  lds
    s_add_u32 m0, s56, 96256
    s_nop 0
    buffer_load_dwordx4 v97, s[8:11], s48 offen  lds
    s_add_u32 m0, s56, 98304
    s_nop 0
    buffer_load_dwordx4 v98, s[8:11], s48 offen  lds
    s_add_u32 m0, s56, 100352
    s_nop 0
    buffer_load_dwordx4 v99, s[8:11], s48 offen  lds
L_sequential_preLN__linear_attn_block__dense_activation_gelu__prompt_kernel_14:
    s_cmp_lg_u32 s66, 0
    s_cbranch_scc1 L_sequential_preLN__linear_attn_block__dense_activation_gelu__prompt_kernel_15_o
    s_mov_b32 s99, 0
    s_branch L_sequential_preLN__linear_attn_block__dense_activation_gelu__prompt_kernel_16_f
L_sequential_preLN__linear_attn_block__dense_activation_gelu__prompt_kernel_16:
L_sequential_preLN__linear_attn_block__dense_activation_gelu__prompt_kernel_16_f:
    buffer_load_dword v124, v3, s[44:47], s92 offen offset:512 sc1
    buffer_load_dword v125, v2, s[44:47], s91 offen sc1
    s_cmp_ge_u32 s54, 14
    s_cbranch_scc1 L_sequential_preLN__linear_attn_block__dense_activation_gelu__prompt_kernel_16_n
    s_cmp_ge_u32 s54, 7
    s_cbranch_scc1 L_sequential_preLN__linear_attn_block__dense_activation_gelu__prompt_kernel_16_2
    buffer_load_dword v126, v5, s[20:23], s53 offen
    s_branch L_sequential_preLN__linear_attn_block__dense_activation_gelu__prompt_kernel_16_i
L_sequential_preLN__linear_attn_block__dense_activation_gelu__prompt_kernel_16_2:
    s_sub_u32 s88, s53, 1835008
    buffer_load_dword v126, v5, s[28:31], s88 offen
L_sequential_preLN__linear_attn_block__dense_activation_gelu__prompt_kernel_16_i:
    s_add_u32 s53, s53, 262144
    s_add_u32 s54, s54, 1
    s_waitcnt vmcnt(1)
    s_branch L_sequential_preLN__linear_attn_block__dense_activation_gelu__prompt_kernel_16_c
L_sequential_preLN__linear_attn_block__dense_activation_gelu__prompt_kernel_16_n:
    s_waitcnt vmcnt(0)
L_sequential_preLN__linear_attn_block__dense_activation_gelu__prompt_kernel_16_c:
    s_add_u32 s99, s99, 1
    v_and_b32 v124, v124, v125
    v_cmp_ne_u32 vcc, 0, v124
    s_nop 0
    s_andn2_b64 s[94:95], s[96:97], vcc
    s_cmp_eq_u64 s[94:95], 0
    s_cbranch_scc1 L_sequential_preLN__linear_attn_block__dense_activation_gelu__prompt_kernel_16_x
    s_cmp_lt_u32 s99, 32
    s_cbranch_scc1 L_sequential_preLN__linear_attn_block__dense_activation_gelu__prompt_kernel_16
    s_lshl_b32 s88, s65, 4
    s_lshl_b32 s89, s66, 2
    s_add_u32 s88, s88, s89
    s_add_u32 s88, s88, s67
    v_mov_b32 v124, 0
    v_mov_b32 v125, 1
    s_mov_b64 exec, 1
    buffer_store_dword v125, v124, s[44:47], s88 offen offset:2048 sc1
    s_mov_b64 exec, -1
L_sequential_preLN__linear_attn_block__dense_activation_gelu__prompt_kernel_16_s:
    buffer_load_dword v124, v3, s[44:47], s92 offen offset:512 sc1
    buffer_load_dword v126, v3, s[44:47], s92 offen offset:2560 sc1
    buffer_load_dword v125, v2, s[44:47], s91 offen sc1
    s_add_u32 s99, s99, 1
    s_waitcnt vmcnt(0)
    v_or_b32 v124, v124, v126
    v_and_b32 v124, v124, v125
    v_cmp_ne_u32 vcc, 0, v124
    s_nop 0
    s_andn2_b64 s[94:95], s[96:97], vcc
    s_cmp_eq_u64 s[94:95], 0
    s_cbranch_scc1 L_sequential_preLN__linear_attn_block__dense_activation_gelu__prompt_kernel_16_x
    s_cmp_lt_u32 s99, 200000
    s_cbranch_scc1 L_sequential_preLN__linear_attn_block__dense_activation_gelu__prompt_kernel_16_s
L_sequential_preLN__linear_attn_block__dense_activation_gelu__prompt_kernel_16_x:
    v_mov_b32 v124, 163752
    v_mov_b32 v125, 1
    s_mov_b64 exec, 1
    ds_add_u32 v124, v125
    s_mov_b64 exec, -1
    s_branch L_sequential_preLN__linear_attn_block__dense_activation_gelu__prompt_kernel_15_e
L_sequential_preLN__linear_attn_block__dense_activation_gelu__prompt_kernel_15_o:
    v_mov_b32 v124, 163752
    s_mov_b32 s99, 0
    s_branch L_sequential_preLN__linear_attn_block__dense_activation_gelu__prompt_kernel_17_f
L_sequential_preLN__linear_attn_block__dense_activation_gelu__prompt_kernel_17:
    s_cmp_lg_u32 s99, 100
    s_cbranch_scc1 L_sequential_preLN__linear_attn_block__dense_activation_gelu__prompt_kernel_17_p
    s_lshl_b32 s88, s65, 4
    s_lshl_b32 s89, s66, 2
    s_add_u32 s88, s88, s89
    s_add_u32 s88, s88, s67
    v_mov_b32 v125, 0
    v_mov_b32 v126, 1
    s_mov_b64 exec, 1
    buffer_store_dword v126, v125, s[44:47], s88 offen offset:2048 sc1
    s_mov_b64 exec, -1
L_sequential_preLN__linear_attn_block__dense_activation_gelu__prompt_kernel_17_p:
    s_sleep 1
L_sequential_preLN__linear_attn_block__dense_activation_gelu__prompt_kernel_17_f:
    ds_read_b32 v125, v124
    s_add_u32 s99, s99, 1
    s_waitcnt lgkmcnt(0)
    v_readfirstlane_b32 s98, v125
    s_cmp_gt_u32 s99, 800000
    s_cbranch_scc1 L_sequential_preLN__linear_attn_block__dense_activation_gelu__prompt_kernel_17_x
    s_cmp_lt_u32 s98, 1
    s_cbranch_scc1 L_sequential_preLN__linear_attn_block__dense_activation_gelu__prompt_kernel_17
L_sequential_preLN__linear_attn_block__dense_activation_gelu__prompt_kernel_17_x:
L_sequential_preLN__linear_attn_block__dense_activation_gelu__prompt_kernel_15_e:
    buffer_load_dwordx4 v[16:19], v10, s[44:47], s79 offen offset:0 sc1
    buffer_load_dwordx4 v[20:23], v10, s[44:47], s79 offen offset:1024 sc1
    buffer_load_dwordx4 v[24:27], v10, s[44:47], s79 offen offset:2048 sc1
    buffer_load_dwordx4 v[28:31], v10, s[44:47], s79 offen offset:3072 sc1
    buffer_load_dwordx4 v[80:83], v10, s[44:47], s80 offen offset:0 sc1
    buffer_load_dwordx4 v[84:87], v10, s[44:47], s81 offen offset:0 sc1
    s_add_u32 s88, s79, 4096
    buffer_load_dwordx4 v[32:35], v10, s[44:47], s88 offen offset:0 sc1
    buffer_load_dwordx4 v[36:39], v10, s[44:47], s88 offen offset:1024 sc1
    buffer_load_dwordx4 v[40:43], v10, s[44:47], s88 offen offset:2048 sc1
    buffer_load_dwordx4 v[44:47], v10, s[44:47], s88 offen offset:3072 sc1
    buffer_load_dwordx4 v[88:91], v10, s[44:47], s80 offen offset:1024 sc1
    buffer_load_dwordx4 v[92:95], v10, s[44:47], s81 offen offset:1024 sc1
    s_add_u32 s88, s79, 8192
    buffer_load_dwordx4 v[48:51], v10, s[44:47], s88 offen offset:0 sc1
    buffer_load_dwordx4 v[52:55], v10, s[44:47], s88 offen offset:1024 sc1
    buffer_load_dwordx4 v[56:59], v10, s[44:47], s88 offen offset:2048 sc1
    buffer_load_dwordx4 v[60:63], v10, s[44:47], s88 offen offset:3072 sc1
    buffer_load_dwordx4 v[96:99], v10, s[44:47], s80 offen offset:2048 sc1
    buffer_load_dwordx4 v[100:103], v10, s[44:47], s81 offen offset:2048 sc1
    s_add_u32 s88, s79, 12288
    buffer_load_dwordx4 v[64:67], v10, s[44:47], s88 offen offset:0 sc1
    buffer_load_dwordx4 v[68:71], v10, s[44:47], s88 offen offset:1024 sc1
    buffer_load_dwordx4 v[72:75], v10, s[44:47], s88 offen offset:2048 sc1
    buffer_load_dwordx4 v[76:79], v10, s[44:47], s88 offen offset:3072 sc1
    buffer_load_dwordx4 v[104:107], v10, s[44:47], s80 offen offset:3072 sc1
    buffer_load_dwordx4 v[108:111], v10, s[44:47], s81 offen offset:3072 sc1
    v_mov_b32 v124, 163780
    v_mov_b32 v125, 1
    s_mov_b64 exec, 1
    ds_add_u32 v124, v125
    s_mov_b64 exec, -1
    v_cmp_gt_u32 vcc, 48, v1
    s_waitcnt vmcnt(18)
    v_cvt_pk_bf16_f32 v16, v16, v17
    v_cvt_pk_bf16_f32 v17, v18, v19
    v_cvt_pk_bf16_f32 v18, v20, v21
    v_cvt_pk_bf16_f32 v19, v22, v23
    v_cvt_pk_bf16_f32 v20, v24, v25
    v_cvt_pk_bf16_f32 v21, v26, v27
    v_cvt_pk_bf16_f32 v22, v28, v29
    v_cvt_pk_bf16_f32 v23, v30, v31
    v_mov_b32_dpp v24, v20 row_newbcast:12 row_mask:0xf bank_mask:0xf
    v_mov_b32_dpp v25, v21 row_newbcast:12 row_mask:0xf bank_mask:0xf
    v_mov_b32_dpp v26, v22 row_newbcast:12 row_mask:0xf bank_mask:0xf
    v_mov_b32_dpp v27, v23 row_newbcast:12 row_mask:0xf bank_mask:0xf
    s_nop 1
    v_mfma_f32_16x16x32_bf16 v[120:123], v[24:27], v[80:83], 0
    v_mfma_f32_16x16x32_bf16 v[112:115], v[16:19], v[80:83], 0
    v_mfma_f32_16x16x32_bf16 v[116:119], v[20:23], v[80:83], 0
    s_nop 5
    v_add_f32 v124, s82, v120
    v_rcp_f32 v124, v124
    s_nop 0
    v_mul_f32 v112, v112, v124
    v_mul_f32 v113, v113, v124
    v_mul_f32 v114, v114, v124
    v_mul_f32 v115, v115, v124
    v_mul_f32 v116, v116, v124
    v_mul_f32 v117, v117, v124
    v_mul_f32 v118, v118, v124
    v_mul_f32 v119, v119, v124
    v_cvt_pk_bf16_f32 v120, v112, v113
    v_cvt_pk_bf16_f32 v121, v114, v115
    v_cvt_pk_bf16_f32 v122, v116, v117
    v_cvt_pk_bf16_f32 v123, v118, v119
    v_cndmask_b32 v122, 0, v122, vcc
    v_cndmask_b32 v123, 0, v123, vcc
    ds_write_b128 v6, v[120:123] offset:0
    s_nop 0
    v_mfma_f32_16x16x32_bf16 v[120:123], v[24:27], v[84:87], 0
    v_mfma_f32_16x16x32_bf16 v[112:115], v[16:19], v[84:87], 0
    v_mfma_f32_16x16x32_bf16 v[116:119], v[20:23], v[84:87], 0
    s_nop 5
    v_add_f32 v125, s82, v120
    v_rcp_f32 v125, v125
    s_nop 0
    v_mul_f32 v112, v112, v125
    v_mul_f32 v113, v113, v125
    v_mul_f32 v114, v114, v125
    v_mul_f32 v115, v115, v125
    v_mul_f32 v116, v116, v125
    v_mul_f32 v117, v117, v125
    v_mul_f32 v118, v118, v125
    v_mul_f32 v119, v119, v125
    v_cvt_pk_bf16_f32 v120, v112, v113
    v_cvt_pk_bf16_f32 v121, v114, v115
    v_cvt_pk_bf16_f32 v122, v116, v117
    v_cvt_pk_bf16_f32 v123, v118, v119
    v_cndmask_b32 v122, 0, v122, vcc
    v_cndmask_b32 v123, 0, v123, vcc
    ds_write_b128 v6, v[120:123] offset:1024
    s_waitcnt vmcnt(12)
    v_cvt_pk_bf16_f32 v32, v32, v33
    v_cvt_pk_bf16_f32 v33, v34, v35
    v_cvt_pk_bf16_f32 v34, v36, v37
    v_cvt_pk_bf16_f32 v35, v38, v39
    v_cvt_pk_bf16_f32 v36, v40, v41
    v_cvt_pk_bf16_f32 v37, v42, v43
    v_cvt_pk_bf16_f32 v38, v44, v45
    v_cvt_pk_bf16_f32 v39, v46, v47
    v_mov_b32_dpp v40, v36 row_newbcast:12 row_mask:0xf bank_mask:0xf
    v_mov_b32_dpp v41, v37 row_newbcast:12 row_mask:0xf bank_mask:0xf
    v_mov_b32_dpp v42, v38 row_newbcast:12 row_mask:0xf bank_mask:0xf
    v_mov_b32_dpp v43, v39 row_newbcast:12 row_mask:0xf bank_mask:0xf
    s_nop 1
    v_mfma_f32_16x16x32_bf16 v[120:123], v[40:43], v[88:91], 0
    v_mfma_f32_16x16x32_bf16 v[112:115], v[32:35], v[88:91], 0
    v_mfma_f32_16x16x32_bf16 v[116:119], v[36:39], v[88:91], 0
    v_mfma_f32_16x16x32_bf16 v[24:27], v[40:43], v[92:95], 0
    v_mfma_f32_16x16x32_bf16 v[16:19], v[32:35], v[92:95], 0
    v_mfma_f32_16x16x32_bf16 v[20:23], v[36:39], v[92:95], 0
    s_nop 2
    v_add_f32 v124, s82, v120
    v_rcp_f32 v124, v124
    s_nop 0
    v_add_f32 v125, s82, v24
    v_rcp_f32 v125, v125
    v_mul_f32 v112, v112, v124
    v_mul_f32 v113, v113, v124
    v_mul_f32 v114, v114, v124
    v_mul_f32 v115, v115, v124
    v_mul_f32 v116, v116, v124
    v_mul_f32 v117, v117, v124
    v_mul_f32 v118, v118, v124
    v_mul_f32 v119, v119, v124
    v_cvt_pk_bf16_f32 v120, v112, v113
    v_cvt_pk_bf16_f32 v121, v114, v115
    v_cvt_pk_bf16_f32 v122, v116, v117
    v_cvt_pk_bf16_f32 v123, v118, v119
    v_cndmask_b32 v122, 0, v122, vcc
    v_cndmask_b32 v123, 0, v123, vcc
    ds_write_b128 v6, v[120:123] offset:2048
    v_mul_f32 v16, v16, v125
    v_mul_f32 v17, v17, v125
    v_mul_f32 v18, v18, v125
    v_mul_f32 v19, v19, v125
    v_mul_f32 v20, v20, v125
    v_mul_f32 v21, v21, v125
    v_mul_f32 v22, v22, v125
    v_mul_f32 v23, v23, v125
    v_cvt_pk_bf16_f32 v24, v16, v17
    v_cvt_pk_bf16_f32 v25, v18, v19
    v_cvt_pk_bf16_f32 v26, v20, v21
    v_cvt_pk_bf16_f32 v27, v22, v23
    v_cndmask_b32 v26, 0, v26, vcc
    v_cndmask_b32 v27, 0, v27, vcc
    ds_write_b128 v6, v[24:27] offset:3072
    s_waitcnt vmcnt(6)
    v_cvt_pk_bf16_f32 v48, v48, v49
    v_cvt_pk_bf16_f32 v49, v50, v51
    v_cvt_pk_bf16_f32 v50, v52, v53
    v_cvt_pk_bf16_f32 v51, v54, v55
    v_cvt_pk_bf16_f32 v52, v56, v57
    v_cvt_pk_bf16_f32 v53, v58, v59
    v_cvt_pk_bf16_f32 v54, v60, v61
    v_cvt_pk_bf16_f32 v55, v62, v63
    v_mov_b32_dpp v56, v52 row_newbcast:12 row_mask:0xf bank_mask:0xf
    v_mov_b32_dpp v57, v53 row_newbcast:12 row_mask:0xf bank_mask:0xf
    v_mov_b32_dpp v58, v54 row_newbcast:12 row_mask:0xf bank_mask:0xf
    v_mov_b32_dpp v59, v55 row_newbcast:12 row_mask:0xf bank_mask:0xf
    s_nop 1
    v_mfma_f32_16x16x32_bf16 v[120:123], v[56:59], v[96:99], 0
    v_mfma_f32_16x16x32_bf16 v[112:115], v[48:51], v[96:99], 0
    v_mfma_f32_16x16x32_bf16 v[116:119], v[52:55], v[96:99], 0
    v_mfma_f32_16x16x32_bf16 v[40:43], v[56:59], v[100:103], 0
    v_mfma_f32_16x16x32_bf16 v[32:35], v[48:51], v[100:103], 0
    v_mfma_f32_16x16x32_bf16 v[36:39], v[52:55], v[100:103], 0
    s_nop 2
    v_add_f32 v124, s82, v120
    v_rcp_f32 v124, v124
    s_nop 0
    v_add_f32 v125, s82, v40
    v_rcp_f32 v125, v125
    v_mul_f32 v112, v112, v124
    v_mul_f32 v113, v113, v124
    v_mul_f32 v114, v114, v124
    v_mul_f32 v115, v115, v124
    v_mul_f32 v116, v116, v124
    v_mul_f32 v117, v117, v124
    v_mul_f32 v118, v118, v124
    v_mul_f32 v119, v119, v124
    v_cvt_pk_bf16_f32 v120, v112, v113
    v_cvt_pk_bf16_f32 v121, v114, v115
    v_cvt_pk_bf16_f32 v122, v116, v117
    v_cvt_pk_bf16_f32 v123, v118, v119
    v_cndmask_b32 v122, 0, v122, vcc
    v_cndmask_b32 v123, 0, v123, vcc
    ds_write_b128 v6, v[120:123] offset:4096
    v_mul_f32 v32, v32, v125
    v_mul_f32 v33, v33, v125
    v_mul_f32 v34, v34, v125
    v_mul_f32 v35, v35, v125
    v_mul_f32 v36, v36, v125
    v_mul_f32 v37, v37, v125
    v_mul_f32 v38, v38, v125
    v_mul_f32 v39, v39, v125
    v_cvt_pk_bf16_f32 v40, v32, v33
    v_cvt_pk_bf16_f32 v41, v34, v35
    v_cvt_pk_bf16_f32 v42, v36, v37
    v_cvt_pk_bf16_f32 v43, v38, v39
    v_cndmask_b32 v42, 0, v42, vcc
    v_cndmask_b32 v43, 0, v43, vcc
    ds_write_b128 v6, v[40:43] offset:5120
    s_waitcnt vmcnt(0)
    v_cvt_pk_bf16_f32 v64, v64, v65
    v_cvt_pk_bf16_f32 v65, v66, v67
    v_cvt_pk_bf16_f32 v66, v68, v69
    v_cvt_pk_bf16_f32 v67, v70, v71
    v_cvt_pk_bf16_f32 v68, v72, v73
    v_cvt_pk_bf16_f32 v69, v74, v75
    v_cvt_pk_bf16_f32 v70, v76, v77
    v_cvt_pk_bf16_f32 v71, v78, v79
    v_mov_b32_dpp v72, v68 row_newbcast:12 row_mask:0xf bank_mask:0xf
    v_mov_b32_dpp v73, v69 row_newbcast:12 row_mask:0xf bank_mask:0xf
    v_mov_b32_dpp v74, v70 row_newbcast:12 row_mask:0xf bank_mask:0xf
    v_mov_b32_dpp v75, v71 row_newbcast:12 row_mask:0xf bank_mask:0xf
    s_nop 1
    v_mfma_f32_16x16x32_bf16 v[120:123], v[72:75], v[104:107], 0
    v_mfma_f32_16x16x32_bf16 v[112:115], v[64:67], v[104:107], 0
    v_mfma_f32_16x16x32_bf16 v[116:119], v[68:71], v[104:107], 0
    v_mfma_f32_16x16x32_bf16 v[56:59], v[72:75], v[108:111], 0
    v_mfma_f32_16x16x32_bf16 v[48:51], v[64:67], v[108:111], 0
    v_mfma_f32_16x16x32_bf16 v[52:55], v[68:71], v[108:111], 0
    s_nop 2
    v_add_f32 v124, s82, v120
    v_rcp_f32 v124, v124
    s_nop 0
    v_add_f32 v125, s82, v56
    v_rcp_f32 v125, v125
    v_mul_f32 v112, v112, v124
    v_mul_f32 v113, v113, v124
    v_mul_f32 v114, v114, v124
    v_mul_f32 v115, v115, v124
    v_mul_f32 v116, v116, v124
    v_mul_f32 v117, v117, v124
    v_mul_f32 v118, v118, v124
    v_mul_f32 v119, v119, v124
    v_cvt_pk_bf16_f32 v120, v112, v113
    v_cvt_pk_bf16_f32 v121, v114, v115
    v_cvt_pk_bf16_f32 v122, v116, v117
    v_cvt_pk_bf16_f32 v123, v118, v119
    v_cndmask_b32 v122, 0, v122, vcc
    v_cndmask_b32 v123, 0, v123, vcc
    ds_write_b128 v6, v[120:123] offset:6144
    v_mul_f32 v48, v48, v125
    v_mul_f32 v49, v49, v125
    v_mul_f32 v50, v50, v125
    v_mul_f32 v51, v51, v125
    v_mul_f32 v52, v52, v125
    v_mul_f32 v53, v53, v125
    v_mul_f32 v54, v54, v125
    v_mul_f32 v55, v55, v125
    v_cvt_pk_bf16_f32 v56, v48, v49
    v_cvt_pk_bf16_f32 v57, v50, v51
    v_cvt_pk_bf16_f32 v58, v52, v53
    v_cvt_pk_bf16_f32 v59, v54, v55
    v_cndmask_b32 v58, 0, v58, vcc
    v_cndmask_b32 v59, 0, v59, vcc
    ds_write_b128 v6, v[56:59] offset:7168
    v_and_b32 v76, 31, v1
    v_lshlrev_b32 v76, 5, v76
    s_lshl_b32 s3, s64, 10
    s_add_u32 s3, s3, 102400
    buffer_load_dword v77, v76, s[44:47], s3 offen sc1
    s_waitcnt lgkmcnt(0)
    v_mov_b32 v124, 163712
    v_mov_b32 v125, 1
    s_mov_b64 exec, 1
    ds_add_u32 v124, v125
    s_mov_b64 exec, -1
    v_mov_b32 v124, 163712
    s_mov_b32 s99, 0
    s_branch L_sequential_preLN__linear_attn_block__dense_activation_gelu__prompt_kernel_18_f
L_sequential_preLN__linear_attn_block__dense_activation_gelu__prompt_kernel_18:
    s_sleep 1
L_sequential_preLN__linear_attn_block__dense_activation_gelu__prompt_kernel_18_f:
    ds_read_b32 v125, v124
    s_add_u32 s99, s99, 1
    s_waitcnt lgkmcnt(0)
    v_readfirstlane_b32 s98, v125
    s_cmp_gt_u32 s99, 800000
    s_cbranch_scc1 L_sequential_preLN__linear_attn_block__dense_activation_gelu__prompt_kernel_18_x
    s_cmp_lt_u32 s98, 8
    s_cbranch_scc1 L_sequential_preLN__linear_attn_block__dense_activation_gelu__prompt_kernel_18
L_sequential_preLN__linear_attn_block__dense_activation_gelu__prompt_kernel_18_x:
    ds_read_b64 v[104:105], v7 offset:0
    ds_read_b64 v[106:107], v7 offset:32
    ds_read_b64 v[108:109], v7 offset:3584
    ds_read_b64 v[110:111], v7 offset:3616
    ds_read_b128 v[32:35], v10 offset:0
    ds_read_b128 v[36:39], v10 offset:1024
    ds_read_b128 v[40:43], v10 offset:2048
    ds_read_b128 v[44:47], v10 offset:3072
    ds_read_b128 v[48:51], v10 offset:4096
    ds_read_b128 v[52:55], v10 offset:5120
    ds_read_b128 v[56:59], v10 offset:6144
    ds_read_b128 v[60:63], v10 offset:7168
    ds_read_b128 v[64:67], v10 offset:8192
    s_waitcnt lgkmcnt(7)
    v_mfma_f32_16x16x32_bf16 v[16:19], a[0:3], v[32:35], 0
    v_mfma_f32_16x16x32_bf16 v[20:23], a[4:7], v[32:35], 0
    ds_read_b128 v[68:71], v10 offset:9216
    v_mfma_f32_16x16x32_bf16 v[24:27], a[0:3], v[36:39], 0
    v_mfma_f32_16x16x32_bf16 v[28:31], a[4:7], v[36:39], 0
    ds_read_b128 v[72:75], v10 offset:10240
    s_waitcnt lgkmcnt(7)
    v_mfma_f32_16x16x32_bf16 v[16:19], a[8:11], v[40:43], v[16:19]
    v_mfma_f32_16x16x32_bf16 v[20:23], a[12:15], v[40:43], v[20:23]
    ds_read_b128 v[32:35], v10 offset:11264
    v_mfma_f32_16x16x32_bf16 v[24:27], a[8:11], v[44:47], v[24:27]
    v_mfma_f32_16x16x32_bf16 v[28:31], a[12:15], v[44:47], v[28:31]
    ds_read_b128 v[36:39], v10 offset:12288
    s_waitcnt lgkmcnt(7)
    v_mfma_f32_16x16x32_bf16 v[16:19], a[16:19], v[48:51], v[16:19]
    v_mfma_f32_16x16x32_bf16 v[20:23], a[20:23], v[48:51], v[20:23]
    ds_read_b128 v[40:43], v10 offset:13312
    v_mfma_f32_16x16x32_bf16 v[24:27], a[16:19], v[52:55], v[24:27]
    v_mfma_f32_16x16x32_bf16 v[28:31], a[20:23], v[52:55], v[28:31]
    ds_read_b128 v[44:47], v10 offset:14336
    s_waitcnt lgkmcnt(7)
    v_mfma_f32_16x16x32_bf16 v[16:19], a[24:27], v[56:59], v[16:19]
    v_mfma_f32_16x16x32_bf16 v[20:23], a[28:31], v[56:59], v[20:23]
    ds_read_b128 v[48:51], v10 offset:15360
    v_mfma_f32_16x16x32_bf16 v[24:27], a[24:27], v[60:63], v[24:27]
    v_mfma_f32_16x16x32_bf16 v[28:31], a[28:31], v[60:63], v[28:31]
    ds_read_b128 v[52:55], v10 offset:16384
    s_waitcnt lgkmcnt(7)
    v_mfma_f32_16x16x32_bf16 v[16:19], a[32:35], v[64:67], v[16:19]
    v_mfma_f32_16x16x32_bf16 v[20:23], a[36:39], v[64:67], v[20:23]
    ds_read_b128 v[56:59], v10 offset:17408
    v_mfma_f32_16x16x32_bf16 v[24:27], a[32:35], v[68:71], v[24:27]
    v_mfma_f32_16x16x32_bf16 v[28:31], a[36:39], v[68:71], v[28:31]
    ds_read_b128 v[60:63], v10 offset:18432
    s_waitcnt lgkmcnt(7)
    v_mfma_f32_16x16x32_bf16 v[16:19], a[40:43], v[72:75], v[16:19]
    v_mfma_f32_16x16x32_bf16 v[20:23], a[44:47], v[72:75], v[20:23]
    ds_read_b128 v[64:67], v10 offset:19456
    v_mfma_f32_16x16x32_bf16 v[24:27], a[40:43], v[32:35], v[24:27]
    v_mfma_f32_16x16x32_bf16 v[28:31], a[44:47], v[32:35], v[28:31]
    ds_read_b128 v[68:71], v10 offset:20480
    s_waitcnt lgkmcnt(7)
    v_mfma_f32_16x16x32_bf16 v[16:19], a[48:51], v[36:39], v[16:19]
    v_mfma_f32_16x16x32_bf16 v[20:23], a[52:55], v[36:39], v[20:23]
    ds_read_b128 v[72:75], v10 offset:21504
    v_mfma_f32_16x16x32_bf16 v[24:27], a[48:51], v[40:43], v[24:27]
    v_mfma_f32_16x16x32_bf16 v[28:31], a[52:55], v[40:43], v[28:31]
    ds_read_b128 v[32:35], v10 offset:22528
    s_waitcnt lgkmcnt(7)
    v_mfma_f32_16x16x32_bf16 v[16:19], a[56:59], v[44:47], v[16:19]
    v_mfma_f32_16x16x32_bf16 v[20:23], a[60:63], v[44:47], v[20:23]
    ds_read_b128 v[36:39], v10 offset:23552
    v_mfma_f32_16x16x32_bf16 v[24:27], a[56:59], v[48:51], v[24:27]
    v_mfma_f32_16x16x32_bf16 v[28:31], a[60:63], v[48:51], v[28:31]
    ds_read_b128 v[40:43], v10 offset:24576
    s_waitcnt lgkmcnt(7)
    v_mfma_f32_16x16x32_bf16 v[16:19], a[64:67], v[52:55], v[16:19]
    v_mfma_f32_16x16x32_bf16 v[20:23], a[68:71], v[52:55], v[20:23]
    ds_read_b128 v[44:47], v10 offset:25600
    v_mfma_f32_16x16x32_bf16 v[24:27], a[64:67], v[56:59], v[24:27]
    v_mfma_f32_16x16x32_bf16 v[28:31], a[68:71], v[56:59], v[28:31]
    ds_read_b128 v[48:51], v10 offset:26624
    s_waitcnt lgkmcnt(7)
    v_mfma_f32_16x16x32_bf16 v[16:19], a[72:75], v[60:63], v[16:19]
    v_mfma_f32_16x16x32_bf16 v[20:23], a[76:79], v[60:63], v[20:23]
    ds_read_b128 v[52:55], v10 offset:27648
    v_mfma_f32_16x16x32_bf16 v[24:27], a[72:75], v[64:67], v[24:27]
    v_mfma_f32_16x16x32_bf16 v[28:31], a[76:79], v[64:67], v[28:31]
    ds_read_b128 v[56:59], v10 offset:28672
    s_waitcnt lgkmcnt(7)
    v_mfma_f32_16x16x32_bf16 v[16:19], a[80:83], v[68:71], v[16:19]
    v_mfma_f32_16x16x32_bf16 v[20:23], a[84:87], v[68:71], v[20:23]
    ds_read_b128 v[60:63], v10 offset:29696
    v_mfma_f32_16x16x32_bf16 v[24:27], a[80:83], v[72:75], v[24:27]
    v_mfma_f32_16x16x32_bf16 v[28:31], a[84:87], v[72:75], v[28:31]
    ds_read_b128 v[64:67], v10 offset:30720
    s_waitcnt lgkmcnt(7)
    v_mfma_f32_16x16x32_bf16 v[16:19], a[88:91], v[32:35], v[16:19]
    v_mfma_f32_16x16x32_bf16 v[20:23], a[92:95], v[32:35], v[20:23]
    ds_read_b128 v[68:71], v10 offset:31744
    v_mfma_f32_16x16x32_bf16 v[24:27], a[88:91], v[36:39], v[24:27]
    v_mfma_f32_16x16x32_bf16 v[28:31], a[92:95], v[36:39], v[28:31]
    s_waitcnt lgkmcnt(6)
    v_mfma_f32_16x16x32_bf16 v[16:19], a[96:99], v[40:43], v[16:19]
    v_mfma_f32_16x16x32_bf16 v[20:23], a[100:103], v[40:43], v[20:23]
    v_mfma_f32_16x16x32_bf16 v[24:27], a[96:99], v[44:47], v[24:27]
    v_mfma_f32_16x16x32_bf16 v[28:31], a[100:103], v[44:47], v[28:31]
    s_waitcnt lgkmcnt(4)
    v_mfma_f32_16x16x32_bf16 v[16:19], a[104:107], v[48:51], v[16:19]
    v_mfma_f32_16x16x32_bf16 v[20:23], a[108:111], v[48:51], v[20:23]
    v_mfma_f32_16x16x32_bf16 v[24:27], a[104:107], v[52:55], v[24:27]
    v_mfma_f32_16x16x32_bf16 v[28:31], a[108:111], v[52:55], v[28:31]
    s_waitcnt lgkmcnt(2)
    v_mfma_f32_16x16x32_bf16 v[16:19], a[112:115], v[56:59], v[16:19]
    v_mfma_f32_16x16x32_bf16 v[20:23], a[116:119], v[56:59], v[20:23]
    v_mfma_f32_16x16x32_bf16 v[24:27], a[112:115], v[60:63], v[24:27]
    v_mfma_f32_16x16x32_bf16 v[28:31], a[116:119], v[60:63], v[28:31]
    s_waitcnt lgkmcnt(0)
    v_mfma_f32_16x16x32_bf16 v[16:19], a[120:123], v[64:67], v[16:19]
    v_mfma_f32_16x16x32_bf16 v[20:23], a[124:127], v[64:67], v[20:23]
    v_mfma_f32_16x16x32_bf16 v[24:27], a[120:123], v[68:71], v[24:27]
    v_mfma_f32_16x16x32_bf16 v[28:31], a[124:127], v[68:71], v[28:31]
    s_waitcnt vmcnt(0)
    v_lshlrev_b32 v80, 16, v104
    v_and_b32 v81, s51, v104
    v_lshlrev_b32 v82, 16, v105
    v_and_b32 v83, s51, v105
    v_lshlrev_b32 v84, 16, v106
    v_and_b32 v85, s51, v106
    v_lshlrev_b32 v86, 16, v107
    v_and_b32 v87, s51, v107
    v_lshlrev_b32 v88, 16, v108
    v_and_b32 v89, s51, v108
    v_lshlrev_b32 v90, 16, v109
    v_and_b32 v91, s51, v109
    v_lshlrev_b32 v92, 16, v110
    v_and_b32 v93, s51, v110
    v_lshlrev_b32 v94, 16, v111
    v_and_b32 v95, s51, v111
    v_add_f32 v16, v16, v80
    v_add_f32 v17, v17, v81
    v_add_f32 v18, v18, v82
    v_add_f32 v19, v19, v83
    v_add_f32 v20, v20, v84
    v_add_f32 v21, v21, v85
    v_add_f32 v22, v22, v86
    v_add_f32 v23, v23, v87
    v_add_f32 v24, v24, v88
    v_add_f32 v25, v25, v89
    v_add_f32 v26, v26, v90
    v_add_f32 v27, v27, v91
    v_add_f32 v28, v28, v92
    v_add_f32 v29, v29, v93
    v_add_f32 v30, v30, v94
    v_add_f32 v31, v31, v95
    v_cvt_pk_bf16_f32 v96, v16, v17
    v_cvt_pk_bf16_f32 v97, v18, v19
    v_cvt_pk_bf16_f32 v98, v20, v21
    v_cvt_pk_bf16_f32 v99, v22, v23
    v_cvt_pk_bf16_f32 v100, v24, v25
    v_cvt_pk_bf16_f32 v101, v26, v27
    v_cvt_pk_bf16_f32 v102, v28, v29
    v_cvt_pk_bf16_f32 v103, v30, v31
    s_cmp_eq_u32 s66, 3
    s_cbranch_scc1 L_sequential_preLN__linear_attn_block__dense_activation_gelu__prompt_kernel_19
    buffer_store_dwordx4 v[96:99], v13, s[44:47], s50 offen offset:0 sc1
    buffer_store_dwordx4 v[100:103], v13, s[44:47], s50 offen offset:256 sc1
    s_branch L_sequential_preLN__linear_attn_block__dense_activation_gelu__prompt_kernel_19_e
L_sequential_preLN__linear_attn_block__dense_activation_gelu__prompt_kernel_19:
    buffer_store_dwordx2 v[96:97], v14, s[44:47], s50 offen offset:0 sc1
    v_mov_b32 v20, 0
    v_mov_b32 v21, 0
    v_mov_b32 v22, 0
    v_mov_b32 v23, 0
    buffer_store_dwordx2 v[100:101], v14, s[44:47], s50 offen offset:256 sc1
    v_mov_b32 v28, 0
    v_mov_b32 v29, 0
    v_mov_b32 v30, 0
    v_mov_b32 v31, 0
L_sequential_preLN__linear_attn_block__dense_activation_gelu__prompt_kernel_19_e:
    v_add_f32 v48, v16, v17
    v_mul_f32 v49, v16, v16
    v_add_f32 v50, v24, v25
    v_mul_f32 v51, v24, v24
    v_fmac_f32 v49, v17, v17
    v_fmac_f32 v51, v25, v25
    v_add_f32 v48, v48, v18
    v_fmac_f32 v49, v18, v18
    v_add_f32 v50, v50, v26
    v_fmac_f32 v51, v26, v26
    v_add_f32 v48, v48, v19
    v_fmac_f32 v49, v19, v19
    v_add_f32 v50, v50, v27
    v_fmac_f32 v51, v27, v27
    v_add_f32 v48, v48, v20
    v_fmac_f32 v49, v20, v20
    v_add_f32 v50, v50, v28
    v_fmac_f32 v51, v28, v28
    v_add_f32 v48, v48, v21
    v_fmac_f32 v49, v21, v21
    v_add_f32 v50, v50, v29
    v_fmac_f32 v51, v29, v29
    v_add_f32 v48, v48, v22
    v_fmac_f32 v49, v22, v22
    v_add_f32 v50, v50, v30
    v_fmac_f32 v51, v30, v30
    v_add_f32 v48, v48, v23
    v_fmac_f32 v49, v23, v23
    v_add_f32 v50, v50, v31
    v_fmac_f32 v51, v31, v31
    v_mov_b32 v52, v48
    v_mov_b32 v53, v49
    v_mov_b32 v54, v50
    v_mov_b32 v55, v51
    v_permlane16_swap_b32 v48, v52
    v_permlane16_swap_b32 v49, v53
    v_permlane16_swap_b32 v50, v54
    v_permlane16_swap_b32 v51, v55
    v_add_f32 v48, v48, v52
    v_add_f32 v49, v49, v53
    v_add_f32 v50, v50, v54
    v_add_f32 v51, v51, v55
    v_mov_b32 v52, v48
    v_mov_b32 v53, v49
    v_mov_b32 v54, v50
    v_mov_b32 v55, v51
    v_permlane32_swap_b32 v48, v52
    v_permlane32_swap_b32 v49, v53
    v_permlane32_swap_b32 v50, v54
    v_permlane32_swap_b32 v51, v55
    v_add_f32 v48, v48, v52
    v_add_f32 v49, v49, v53
    v_add_f32 v50, v50, v54
    v_add_f32 v51, v51, v55
    v_bfe_u32 v124, v1, 4, 1
    v_cmp_eq_u32 vcc, 1, v124
    s_nop 1
    v_cndmask_b32 v48, v48, v50, vcc
    v_cndmask_b32 v49, v49, v51, vcc
    buffer_store_dwordx2 v[48:49], v15, s[44:47], s52 offen  sc1
    s_cmp_ge_u32 s65, 14
    s_cselect_b32 s83, 1, 0
    s_lshl_b32 s75, s64, 1
    s_add_u32 s75, s75, s83
    s_mul_i32 s89, s83, 14
    s_sub_u32 s91, s65, s89
    s_mul_i32 s88, s75, 114688
    s_mul_i32 s77, s66, 7168
    s_lshl_b32 s89, s83, 1
    s_add_u32 s89, s89, s66
    s_and_b32 s89, s89, 3
    s_mul_i32 s89, s89, 7168
    s_add_u32 s76, s88, s89
    s_add_u32 s76, s76, 3145728
    s_lshl_b32 s88, s75, 14
    s_add_u32 s89, s91, s66
    s_and_b32 s89, s89, 3
    s_lshl_b32 s89, s89, 12
    s_add_u32 s78, s88, s89
    s_add_u32 s78, s78, 5242880
    s_add_u32 s88, s91, 0
    s_and_b32 s88, s88, 3
    s_mul_i32 s88, s88, 28672
    s_add_u32 s60, s76, s88
    s_add_u32 s88, s91, 1
    s_and_b32 s88, s88, 3
    s_mul_i32 s88, s88, 28672
    s_add_u32 s61, s76, s88
    s_add_u32 s88, s91, 2
    s_and_b32 s88, s88, 3
    s_mul_i32 s88, s88, 28672
    s_add_u32 s62, s76, s88
    s_add_u32 s88, s91, 3
    s_and_b32 s88, s88, 3
    s_mul_i32 s88, s88, 28672
    s_add_u32 s63, s76, s88
    v_and_b32 v112, 31, v1
    v_lshlrev_b32 v114, 4, v112
    v_lshrrev_b32 v113, 5, v1
    v_lshl_add_u32 v8, v113, 11, v114
    s_lshl_b32 s88, s83, 8
    s_add_u32 s92, s67, s88
    s_mov_b32 s99, 0
    s_branch L_sequential_preLN__linear_attn_block__dense_activation_gelu__prompt_kernel_20_c
L_sequential_preLN__linear_attn_block__dense_activation_gelu__prompt_kernel_20:
    buffer_load_dword v77, v76, s[44:47], s3 offen sc1
    s_add_u32 s99, s99, 1
    s_waitcnt vmcnt(0)
L_sequential_preLN__linear_attn_block__dense_activation_gelu__prompt_kernel_20_c:
    v_cmp_ne_u32 s[94:95], 0, v77
    s_cmp_gt_u32 s99, 200000
    s_cbranch_scc1 L_sequential_preLN__linear_attn_block__dense_activation_gelu__prompt_kernel_20_x
    s_cmp_eq_u64 s[94:95], -1
    s_cbranch_scc0 L_sequential_preLN__linear_attn_block__dense_activation_gelu__prompt_kernel_20
L_sequential_preLN__linear_attn_block__dense_activation_gelu__prompt_kernel_20_x:
    s_getreg_b32 s88, hwreg(HW_REG_XCC_ID, 0, 4)
    s_or_b32 s88, s88, 0x80
    v_cmp_eq_u32 s[94:95], s88, v77
    s_nop 0
    s_cmp_eq_u64 s[94:95], -1
    s_cselect_b32 s70, 0, 268435456
    s_lshl_b32 s88, s65, 4
    s_lshl_b32 s89, s66, 2
    s_add_u32 s88, s88, s89
    s_add_u32 s88, s88, s67
    v_mov_b32 v112, 0
    v_mov_b32 v113, 1
    s_waitcnt vmcnt(0)
    s_mov_b64 exec, 1
    buffer_store_dword v113, v112, s[4:7], s88 offen offset:1024
    s_mov_b64 exec, -1
    s_lshl_b32 s88, s65, 4
    s_lshl_b32 s89, s66, 2
    s_add_u32 s88, s88, s89
    s_add_u32 s88, s88, s67
    v_mov_b32 v112, 0
    v_mov_b32 v113, 1
    s_mov_b64 exec, 1
    buffer_store_dword v113, v112, s[68:71], s88 offen offset:3072 sc1
    s_mov_b64 exec, -1
    s_cmp_lt_u32 s65, 28
    s_cbranch_scc1 L_sequential_preLN__linear_attn_block__dense_activation_gelu__prompt_kernel_21
    s_sub_u32 s88, s65, 28
    s_lshl_b32 s88, s88, 2
    s_add_u32 s88, s88, s66
    s_lshl_b32 s88, s88, 13
    s_branch LgbendY_sequential_preLN__linear_attn_block__dense_activation_gelu__prompt_kernel
L_sequential_preLN__linear_attn_block__dense_activation_gelu__prompt_kernel_21:
    s_mul_i32 s88, s65, 37
    s_lshr_b32 s88, s88, 8
    s_mul_i32 s89, s88, 7
    s_sub_u32 s79, s65, s89
    s_lshl_b32 s74, s64, 2
    s_add_u32 s74, s74, s88
    s_add_u32 s93, s88, s79
    s_mul_i32 s80, s66, 401408
    s_lshl_b32 s88, s79, 7
    s_add_u32 s80, s80, s88
    s_mul_i32 s81, s66, 10240
    s_add_u32 s81, s81, 120832
    v_lshrrev_b32 v112, 3, v1
    v_mul_u32_u24 v2, 896, v112
    v_bfe_u32 v113, v1, 2, 1
    v_bfe_u32 v114, v1, 4, 1
    v_xor_b32 v113, v113, v114
    v_lshl_add_u32 v2, v113, 6, v2
    v_and_b32 v113, 3, v1
    v_lshl_add_u32 v2, v113, 4, v2
    v_lshrrev_b32 v112, 5, v1
    v_bfe_u32 v113, v1, 2, 2
    v_lshl_add_u32 v112, v112, 3, v113
    v_lshlrev_b32 v4, 7, v112
    v_bfe_u32 v113, v1, 3, 1
    v_lshl_add_u32 v4, v113, 6, v4
    v_bfe_u32 v113, v1, 4, 1
    v_lshl_add_u32 v4, v113, 5, v4
    v_and_b32 v113, 3, v1
    v_lshl_add_u32 v4, v113, 3, v4
    v_xor_b32 v5, 64, v4
    s_mul_i32 s82, s66, 14336
    v_add_u32 v6, s82, v4
    v_add_u32 v7, s82, v5
    v_add_u32 v4, s81, v4
    v_add_u32 v5, s81, v5
    s_mul_i32 s88, s74, 224
    s_mul_i32 s89, s66, 28
    s_add_u32 s88, s88, s89
    s_lshl_b32 s88, s88, 10
    s_add_u32 s76, s88, 6291456
    s_add_u32 s88, s93, 0
    s_and_b32 s88, s88, 3
    s_mul_i32 s89, s88, 100352
    s_add_u32 s48, s80, s89
    s_mul_i32 s89, s88, 7168
    s_add_u32 s52, s76, s89
    s_add_u32 s53, s52, 114688
    s_add_u32 s88, s93, 1
    s_and_b32 s88, s88, 3
    s_mul_i32 s89, s88, 100352
    s_add_u32 s49, s80, s89
    s_mul_i32 s89, s88, 7168
    s_add_u32 s54, s76, s89
    s_add_u32 s55, s54, 114688
    s_add_u32 s88, s93, 2
    s_and_b32 s88, s88, 3
    s_mul_i32 s89, s88, 100352
    s_add_u32 s50, s80, s89
    s_mul_i32 s89, s88, 7168
    s_add_u32 s56, s76, s89
    s_add_u32 s57, s56, 114688
    s_add_u32 s88, s93, 3
    s_and_b32 s88, s88, 3
    s_mul_i32 s89, s88, 100352
    s_add_u32 s51, s80, s89
    s_mul_i32 s89, s88, 7168
    s_add_u32 s58, s76, s89
    s_add_u32 s59, s58, 114688
    s_and_b32 s88, s74, 1
    s_lshl_b32 s88, s88, 1
    s_lshr_b32 s89, s66, 1
    s_add_u32 s88, s88, s89
    s_sub_u32 s88, s88, s91
    s_and_b32 s88, s88, 3
    s_mul_i32 s90, s88, 29696
    s_and_b32 s89, s66, 1
    s_lshl_b32 s89, s89, 8
    s_add_u32 s90, s90, s89
    s_lshl_b32 s89, s83, 1
    s_lshl_b32 s88, s79, 6
    v_lshrrev_b32 v112, 3, v1
    v_and_b32 v113, 7, v1
    v_lshlrev_b32 v114, 3, v113
    v_add_u32 v114, s88, v114
    v_add_u32 v114, 0, v114
    v_mul_u32_u24 v115, 586, v114
    v_lshrrev_b32 v115, 16, v115
    v_mul_u32_u24 v116, 112, v115
    v_sub_u32 v114, v114, v116
    v_subrev_u32 v115, s89, v115
    v_and_b32 v115, 3, v115
    v_mul_u32_u24 v115, 7, v115
    v_lshrrev_b32 v116, 5, v114
    v_lshl_add_u32 v115, v116, 1, v115
    v_lshlrev_b32 v13, 10, v115
    v_lshl_add_u32 v13, v112, 4, v13
    v_bfe_u32 v115, v114, 2, 1
    v_bfe_u32 v116, v114, 3, 1
    v_bfe_u32 v117, v114, 4, 1
    v_lshlrev_b32 v118, 10, v116
    v_lshl_add_u32 v118, v115, 9, v118
    v_lshl_add_u32 v118, v117, 3, v118
    v_lshlrev_b32 v119, 9, v116
    v_lshl_add_u32 v119, v115, 3, v119
    v_cmp_gt_u32 vcc, 96, v114
    s_nop 1
    v_cndmask_b32 v118, v119, v118, vcc
    v_add3_u32 v13, v13, v118, s90
    v_lshlrev_b32 v114, 3, v113
    v_add_u32 v114, s88, v114
    v_add_u32 v114, 4, v114
    v_mul_u32_u24 v115, 586, v114
    v_lshrrev_b32 v115, 16, v115
    v_mul_u32_u24 v116, 112, v115
    v_sub_u32 v114, v114, v116
    v_subrev_u32 v115, s89, v115
    v_and_b32 v115, 3, v115
    v_mul_u32_u24 v115, 7, v115
    v_lshrrev_b32 v116, 5, v114
    v_lshl_add_u32 v115, v116, 1, v115
    v_lshlrev_b32 v14, 10, v115
    v_lshl_add_u32 v14, v112, 4, v14
    v_bfe_u32 v115, v114, 2, 1
    v_bfe_u32 v116, v114, 3, 1
    v_bfe_u32 v117, v114, 4, 1
    v_lshlrev_b32 v118, 10, v116
    v_lshl_add_u32 v118, v115, 9, v118
    v_lshl_add_u32 v118, v117, 3, v118
    v_lshlrev_b32 v119, 9, v116
    v_lshl_add_u32 v119, v115, 3, v119
    v_cmp_gt_u32 vcc, 96, v114
    s_nop 1
    v_cndmask_b32 v118, v119, v118, vcc
    v_add3_u32 v14, v14, v118, s90
    s_waitcnt lgkmcnt(0)
    v_mov_b32 v112, 163712
    v_mov_b32 v113, 1
    s_mov_b64 exec, 1
    ds_add_u32 v112, v113
    s_mov_b64 exec, -1
    v_mov_b32 v112, 163712
    s_mov_b32 s99, 0
    s_branch L_sequential_preLN__linear_attn_block__dense_activation_gelu__prompt_kernel_22_f
L_sequential_preLN__linear_attn_block__dense_activation_gelu__prompt_kernel_22:
    s_sleep 1
L_sequential_preLN__linear_attn_block__dense_activation_gelu__prompt_kernel_22_f:
    ds_read_b32 v113, v112
    s_add_u32 s99, s99, 1
    s_waitcnt lgkmcnt(0)
    v_readfirstlane_b32 s98, v113
    s_cmp_gt_u32 s99, 800000
    s_cbranch_scc1 L_sequential_preLN__linear_attn_block__dense_activation_gelu__prompt_kernel_22_x
    s_cmp_lt_u32 s98, 12
    s_cbranch_scc1 L_sequential_preLN__linear_attn_block__dense_activation_gelu__prompt_kernel_22
L_sequential_preLN__linear_attn_block__dense_activation_gelu__prompt_kernel_22_x:
    v_mov_b32 v112, 163748
    s_mov_b32 s99, 0
    s_branch L_sequential_preLN__linear_attn_block__dense_activation_gelu__prompt_kernel_23_f
L_sequential_preLN__linear_attn_block__dense_activation_gelu__prompt_kernel_23:
    s_sleep 1
L_sequential_preLN__linear_attn_block__dense_activation_gelu__prompt_kernel_23_f:
    ds_read_b32 v113, v112
    s_add_u32 s99, s99, 1
    s_waitcnt lgkmcnt(0)
    v_readfirstlane_b32 s98, v113
    s_cmp_gt_u32 s99, 800000
    s_cbranch_scc1 L_sequential_preLN__linear_attn_block__dense_activation_gelu__prompt_kernel_23_x
    s_cmp_lt_u32 s98, 4
    s_cbranch_scc1 L_sequential_preLN__linear_attn_block__dense_activation_gelu__prompt_kernel_23
L_sequential_preLN__linear_attn_block__dense_activation_gelu__prompt_kernel_23_x:
    s_mov_b32 s99, 0
    s_branch L_sequential_preLN__linear_attn_block__dense_activation_gelu__prompt_kernel_24_f
L_sequential_preLN__linear_attn_block__dense_activation_gelu__prompt_kernel_24:
    s_sleep 1
L_sequential_preLN__linear_attn_block__dense_activation_gelu__prompt_kernel_24_f:
    buffer_load_dword v112, v3, s[44:47], s92 offen offset:1024 sc1
    s_waitcnt vmcnt(0)
L_sequential_preLN__linear_attn_block__dense_activation_gelu__prompt_kernel_24_c:
    s_add_u32 s99, s99, 1
    v_cmp_ne_u32 vcc, 0, v112
    s_nop 0
    s_andn2_b64 s[94:95], s[96:97], vcc
    s_cmp_eq_u64 s[94:95], 0
    s_cbranch_scc1 L_sequential_preLN__linear_attn_block__dense_activation_gelu__prompt_kernel_24_x
    s_cmp_lt_u32 s99, 32
    s_cbranch_scc1 L_sequential_preLN__linear_attn_block__dense_activation_gelu__prompt_kernel_24
L_sequential_preLN__linear_attn_block__dense_activation_gelu__prompt_kernel_24_s:
    buffer_load_dword v112, v3, s[44:47], s92 offen offset:1024 sc1
    buffer_load_dword v114, v3, s[44:47], s92 offen offset:3072 sc1
    s_add_u32 s99, s99, 1
    s_waitcnt vmcnt(0)
    v_or_b32 v112, v112, v114
    v_cmp_ne_u32 vcc, 0, v112
    s_nop 0
    s_andn2_b64 s[94:95], s[96:97], vcc
    s_cmp_eq_u64 s[94:95], 0
    s_cbranch_scc1 L_sequential_preLN__linear_attn_block__dense_activation_gelu__prompt_kernel_24_x
    s_cmp_lt_u32 s99, 200000
    s_cbranch_scc1 L_sequential_preLN__linear_attn_block__dense_activation_gelu__prompt_kernel_24_s
L_sequential_preLN__linear_attn_block__dense_activation_gelu__prompt_kernel_24_x:
    buffer_load_dwordx4 v[16:19], v8, s[44:47], s78 offen offset:0 sc1
    buffer_load_dwordx4 v[20:23], v8, s[44:47], s78 offen offset:512 sc1
    buffer_load_dwordx4 v[24:27], v8, s[44:47], s78 offen offset:1024 sc1
    buffer_load_dwordx4 v[28:31], v8, s[44:47], s78 offen offset:1536 sc1
    s_add_u32 m0, s77, 29696
    s_nop 0
    buffer_load_dwordx4 v10, s[44:47], s61 offen sc1 lds
    buffer_load_dwordx4 v10, s[44:47], s61 offen offset:1024 sc1 lds
    buffer_load_dwordx4 v10, s[44:47], s61 offen offset:2048 sc1 lds
    buffer_load_dwordx4 v10, s[44:47], s61 offen offset:3072 sc1 lds
    s_add_u32 m0, s77, 33792
    s_add_u32 s88, s61, 4096
    buffer_load_dwordx4 v10, s[44:47], s88 offen sc1 lds
    buffer_load_dwordx4 v10, s[44:47], s88 offen offset:1024 sc1 lds
    buffer_load_dwordx4 v10, s[44:47], s88 offen offset:2048 sc1 lds
    s_waitcnt vmcnt(7)
    v_add_f32 v16, v16, v24
    v_add_f32 v17, v17, v25
    v_add_f32 v18, v18, v26
    v_add_f32 v19, v19, v27
    v_add_f32 v20, v20, v28
    v_add_f32 v21, v21, v29
    v_add_f32 v22, v22, v30
    v_add_f32 v23, v23, v31
    v_add_f32 v16, v16, v18
    v_add_f32 v17, v17, v19
    v_add_f32 v20, v20, v22
    v_add_f32 v21, v21, v23
    v_add_f32 v16, v16, v20
    v_add_f32 v17, v17, v21
    v_mov_b32 v18, v16
    v_mov_b32 v19, v17
    s_nop 0
    v_permlane32_swap_b32 v16, v18
    v_permlane32_swap_b32 v17, v19
    v_add_f32 v16, v16, v18
    v_add_f32 v17, v17, v19
    v_mul_f32 v16, 0xbb124925, v16
    v_mul_f32 v17, 0x3b124925, v17
    v_fma_f32 v17, -v16, v16, v17
    v_max_f32 v17, 0, v17
    v_add_f32 v17, 0x3727c5ac, v17
    v_rsq_f32 v18, v17
    v_sqrt_f32 v22, v17
    v_mul_f32 v20, 0xc0135761, v18
    v_mul_f32 v21, v18, v18
    v_mul_f32 v21, v21, v18
    v_mul_f32 v21, 0xbdd2d3e8, v21
    v_mov_b32 v23, 0
    v_cvt_pk_bf16_f32 v24, v16, v16
    v_and_b32 v28, 0xffff0000, v24
    v_sub_f32 v28, v16, v28
    v_cvt_pk_bf16_f32 v25, v28, v22
    v_and_b32 v28, 0xffff0000, v25
    v_sub_f32 v28, v22, v28
    v_cvt_pk_bf16_f32 v26, v28, v23
    v_mov_b32 v27, 0
    v_cmp_gt_u32 vcc, 32, v1
    s_nop 1
    v_cndmask_b32 v24, 0, v24, vcc
    v_cndmask_b32 v25, 0, v25, vcc
    v_cndmask_b32 v26, 0, v26, vcc
    s_mul_i32 s88, s66, 29696
    s_add_u32 s88, s88, 28672
    v_add_u32 v28, s88, v10
    v_and_b32 v29, 31, v1
    v_lshlrev_b32 v29, 4, v29
    s_lshl_b32 s88, s66, 9
    s_add_u32 s88, s88, 118784
    v_add_u32 v29, s88, v29
    ds_write_b128 v28, v[24:27]
    ds_write_b128 v29, v[20:23]
    s_waitcnt lgkmcnt(0)
    s_waitcnt vmcnt(0)
    v_mov_b32 v112, 163724
    v_mov_b32 v113, 1
    s_mov_b64 exec, 1
    ds_add_u32 v112, v113
    s_mov_b64 exec, -1
    s_add_u32 m0, s77, 59392
    s_nop 0
    buffer_load_dwordx4 v10, s[44:47], s62 offen sc1 lds
    buffer_load_dwordx4 v10, s[44:47], s62 offen offset:1024 sc1 lds
    buffer_load_dwordx4 v10, s[44:47], s62 offen offset:2048 sc1 lds
    buffer_load_dwordx4 v10, s[44:47], s62 offen offset:3072 sc1 lds
    s_add_u32 m0, s77, 63488
    s_add_u32 s88, s62, 4096
    buffer_load_dwordx4 v10, s[44:47], s88 offen sc1 lds
    buffer_load_dwordx4 v10, s[44:47], s88 offen offset:1024 sc1 lds
    buffer_load_dwordx4 v10, s[44:47], s88 offen offset:2048 sc1 lds
    s_add_u32 m0, s77, 89088
    s_nop 0
    buffer_load_dwordx4 v10, s[44:47], s63 offen sc1 lds
    buffer_load_dwordx4 v10, s[44:47], s63 offen offset:1024 sc1 lds
    buffer_load_dwordx4 v10, s[44:47], s63 offen offset:2048 sc1 lds
    buffer_load_dwordx4 v10, s[44:47], s63 offen offset:3072 sc1 lds
    s_add_u32 m0, s77, 93184
    s_add_u32 s88, s63, 4096
    buffer_load_dwordx4 v10, s[44:47], s88 offen sc1 lds
    buffer_load_dwordx4 v10, s[44:47], s88 offen offset:1024 sc1 lds
    buffer_load_dwordx4 v10, s[44:47], s88 offen offset:2048 sc1 lds
    v_add_u32 v9, 6144, v2
    s_waitcnt vmcnt(7)
    v_mov_b32 v112, 163728
    v_mov_b32 v113, 1
    s_mov_b64 exec, 1
    ds_add_u32 v112, v113
    s_mov_b64 exec, -1
    s_add_u32 m0, s81, 0
    s_nop 0
    buffer_load_dwordx4 v2, s[28:31], s48 offen  lds
    buffer_load_dwordx4 v9, s[28:31], s48 offen offset:1024 lds
    s_add_u32 m0, s81, 2048
    s_add_u32 s88, s48, 14336
    buffer_load_dwordx4 v2, s[28:31], s88 offen  lds
    buffer_load_dwordx4 v9, s[28:31], s88 offen offset:1024 lds
    s_add_u32 m0, s81, 4096
    s_add_u32 s88, s48, 28672
    buffer_load_dwordx4 v2, s[28:31], s88 offen  lds
    buffer_load_dwordx4 v9, s[28:31], s88 offen offset:1024 lds
    s_waitcnt vmcnt(6)
    v_mov_b32 v112, 163732
    v_mov_b32 v113, 1
    s_mov_b64 exec, 1
    ds_add_u32 v112, v113
    s_mov_b64 exec, -1
    s_add_u32 m0, s81, 6144
    s_add_u32 s88, s48, 43008
    buffer_load_dwordx4 v2, s[28:31], s88 offen  lds
    buffer_load_dwordx4 v9, s[28:31], s88 offen offset:1024 lds
    s_add_u32 m0, s81, 8192
    s_add_u32 s88, s48, 57344
    buffer_load_dwordx4 v2, s[28:31], s88 offen  lds
    buffer_load_dwordx4 v9, s[28:31], s88 offen offset:1024 lds
    s_waitcnt vmcnt(8)
    ds_read_b64_tr_b16 a[0:1], v4 offset:0
    ds_read_b64_tr_b16 a[2:3], v4 offset:512
    ds_read_b64_tr_b16 a[4:5], v5 offset:0
    ds_read_b64_tr_b16 a[6:7], v5 offset:512
    s_waitcnt vmcnt(6)
    ds_read_b64_tr_b16 a[8:9], v4 offset:2048
    ds_read_b64_tr_b16 a[10:11], v4 offset:2560
    ds_read_b64_tr_b16 a[12:13], v5 offset:2048
    ds_read_b64_tr_b16 a[14:15], v5 offset:2560
    s_waitcnt lgkmcnt(4)
    s_add_u32 m0, s81, 0
    s_add_u32 s88, s48, 71680
    buffer_load_dwordx4 v2, s[28:31], s88 offen  lds
    buffer_load_dwordx4 v9, s[28:31], s88 offen offset:1024 lds
    s_waitcnt vmcnt(6)
    ds_read_b64_tr_b16 a[16:17], v4 offset:4096
    ds_read_b64_tr_b16 a[18:19], v4 offset:4608
    ds_read_b64_tr_b16 a[20:21], v5 offset:4096
    ds_read_b64_tr_b16 a[22:23], v5 offset:4608
    s_waitcnt lgkmcnt(4)
    s_add_u32 m0, s81, 2048
    s_add_u32 s88, s48, 86016
    buffer_load_dwordx4 v2, s[28:31], s88 offen  lds
    buffer_load_dwordx4 v9, s[28:31], s88 offen offset:1024 lds
    s_waitcnt vmcnt(6)
    ds_read_b64_tr_b16 a[24:25], v4 offset:6144
    ds_read_b64_tr_b16 a[26:27], v4 offset:6656
    ds_read_b64_tr_b16 a[28:29], v5 offset:6144
    ds_read_b64_tr_b16 a[30:31], v5 offset:6656
    s_waitcnt lgkmcnt(4)
    s_add_u32 m0, s81, 4096
    s_nop 0
    buffer_load_dwordx4 v2, s[28:31], s49 offen  lds
    buffer_load_dwordx4 v9, s[28:31], s49 offen offset:1024 lds
    v_mov_b32 v112, 163720
    s_mov_b32 s99, 0
    s_branch L_sequential_preLN__linear_attn_block__dense_activation_gelu__prompt_kernel_25_f
L_sequential_preLN__linear_attn_block__dense_activation_gelu__prompt_kernel_25:
    s_sleep 1
L_sequential_preLN__linear_attn_block__dense_activation_gelu__prompt_kernel_25_f:
    ds_read_b32 v113, v112
    s_add_u32 s99, s99, 1
    s_waitcnt lgkmcnt(0)
    v_readfirstlane_b32 s98, v113
    s_cmp_gt_u32 s99, 800000
    s_cbranch_scc1 L_sequential_preLN__linear_attn_block__dense_activation_gelu__prompt_kernel_25_x
    s_cmp_lt_u32 s98, 4
    s_cbranch_scc1 L_sequential_preLN__linear_attn_block__dense_activation_gelu__prompt_kernel_25
L_sequential_preLN__linear_attn_block__dense_activation_gelu__prompt_kernel_25_x:
    v_mov_b32 v112, 163732
    s_mov_b32 s99, 0
    s_branch L_sequential_preLN__linear_attn_block__dense_activation_gelu__prompt_kernel_26_f
L_sequential_preLN__linear_attn_block__dense_activation_gelu__prompt_kernel_26:
    s_sleep 1
L_sequential_preLN__linear_attn_block__dense_activation_gelu__prompt_kernel_26_f:
    ds_read_b32 v113, v112
    s_add_u32 s99, s99, 1
    s_waitcnt lgkmcnt(0)
    v_readfirstlane_b32 s98, v113
    s_cmp_gt_u32 s99, 800000
    s_cbranch_scc1 L_sequential_preLN__linear_attn_block__dense_activation_gelu__prompt_kernel_26_x
    s_cmp_lt_u32 s98, 4
    s_cbranch_scc1 L_sequential_preLN__linear_attn_block__dense_activation_gelu__prompt_kernel_26
L_sequential_preLN__linear_attn_block__dense_activation_gelu__prompt_kernel_26_x:
    ds_read_b64 v[120:121], v13 offset:0
    ds_read_b64 v[122:123], v14 offset:0
    ds_read_b64 v[124:125], v13 offset:128
    ds_read_b64 v[126:127], v14 offset:128
    s_waitcnt lgkmcnt(0)
    v_mov_b32 v112, 163736
    v_mov_b32 v113, 1
    s_mov_b64 exec, 1
    ds_add_u32 v112, v113
    s_mov_b64 exec, -1
    s_waitcnt vmcnt(6)
    ds_read_b64_tr_b16 a[32:33], v4 offset:8192
    ds_read_b64_tr_b16 a[34:35], v4 offset:8704
    ds_read_b64_tr_b16 a[36:37], v5 offset:8192
    ds_read_b64_tr_b16 a[38:39], v5 offset:8704
    s_add_u32 m0, s81, 6144
    s_add_u32 s88, s49, 14336
    buffer_load_dwordx4 v2, s[28:31], s88 offen  lds
    buffer_load_dwordx4 v9, s[28:31], s88 offen offset:1024 lds
    s_waitcnt vmcnt(6)
    ds_read_b64_tr_b16 a[40:41], v4 offset:0
    ds_read_b64_tr_b16 a[42:43], v4 offset:512
    ds_read_b64_tr_b16 a[44:45], v5 offset:0
    ds_read_b64_tr_b16 a[46:47], v5 offset:512
    s_waitcnt lgkmcnt(4)
    s_add_u32 m0, s81, 8192
    s_add_u32 s88, s49, 28672
    buffer_load_dwordx4 v2, s[28:31], s88 offen  lds
    buffer_load_dwordx4 v9, s[28:31], s88 offen offset:1024 lds
    s_waitcnt vmcnt(6)
    ds_read_b64_tr_b16 a[48:49], v4 offset:2048
    ds_read_b64_tr_b16 a[50:51], v4 offset:2560
    ds_read_b64_tr_b16 a[52:53], v5 offset:2048
    ds_read_b64_tr_b16 a[54:55], v5 offset:2560
    s_waitcnt lgkmcnt(4)
    s_add_u32 m0, s81, 0
    s_add_u32 s88, s49, 43008
    buffer_load_dwordx4 v2, s[28:31], s88 offen  lds
    buffer_load_dwordx4 v9, s[28:31], s88 offen offset:1024 lds
    s_waitcnt vmcnt(6)
    ds_read_b64_tr_b16 a[56:57], v4 offset:4096
    ds_read_b64_tr_b16 a[58:59], v4 offset:4608
    ds_read_b64_tr_b16 a[60:61], v5 offset:4096
    ds_read_b64_tr_b16 a[62:63], v5 offset:4608
    s_waitcnt lgkmcnt(4)
    s_add_u32 m0, s81, 2048
    s_add_u32 s88, s49, 57344
    buffer_load_dwordx4 v2, s[28:31], s88 offen  lds
    buffer_load_dwordx4 v9, s[28:31], s88 offen offset:1024 lds
    s_waitcnt vmcnt(6)
    ds_read_b64_tr_b16 a[64:65], v4 offset:6144
    ds_read_b64_tr_b16 a[66:67], v4 offset:6656
    ds_read_b64_tr_b16 a[68:69], v5 offset:6144
    ds_read_b64_tr_b16 a[70:71], v5 offset:6656
    s_waitcnt lgkmcnt(4)
    s_add_u32 m0, s81, 4096
    s_add_u32 s88, s49, 71680
    buffer_load_dwordx4 v2, s[28:31], s88 offen  lds
    buffer_load_dwordx4 v9, s[28:31], s88 offen offset:1024 lds
    v_mov_b32 v112, 163736
    s_mov_b32 s99, 0
    s_branch L_sequential_preLN__linear_attn_block__dense_activation_gelu__prompt_kernel_27_f
L_sequential_preLN__linear_attn_block__dense_activation_gelu__prompt_kernel_27:
    s_sleep 1
L_sequential_preLN__linear_attn_block__dense_activation_gelu__prompt_kernel_27_f:
    ds_read_b32 v113, v112
    s_add_u32 s99, s99, 1
    s_waitcnt lgkmcnt(0)
    v_readfirstlane_b32 s98, v113
    s_cmp_gt_u32 s99, 800000
    s_cbranch_scc1 L_sequential_preLN__linear_attn_block__dense_activation_gelu__prompt_kernel_27_x
    s_cmp_lt_u32 s98, 8
    s_cbranch_scc1 L_sequential_preLN__linear_attn_block__dense_activation_gelu__prompt_kernel_27
L_sequential_preLN__linear_attn_block__dense_activation_gelu__prompt_kernel_27_x:
    v_mov_b32 v112, 163740
    s_mov_b32 s99, 0
    s_branch L_sequential_preLN__linear_attn_block__dense_activation_gelu__prompt_kernel_28_f
L_sequential_preLN__linear_attn_block__dense_activation_gelu__prompt_kernel_28:
    s_sleep 1
L_sequential_preLN__linear_attn_block__dense_activation_gelu__prompt_kernel_28_f:
    ds_read_b32 v113, v112
    s_add_u32 s99, s99, 1
    s_waitcnt lgkmcnt(0)
    v_readfirstlane_b32 s98, v113
    s_cmp_gt_u32 s99, 800000
    s_cbranch_scc1 L_sequential_preLN__linear_attn_block__dense_activation_gelu__prompt_kernel_28_x
    s_cmp_lt_u32 s98, 4
    s_cbranch_scc1 L_sequential_preLN__linear_attn_block__dense_activation_gelu__prompt_kernel_28
L_sequential_preLN__linear_attn_block__dense_activation_gelu__prompt_kernel_28_x:
    s_add_u32 m0, s82, 0
    s_nop 0
    buffer_load_dwordx4 v2, s[28:31], s51 offen  lds
    buffer_load_dwordx4 v9, s[28:31], s51 offen offset:1024 lds
    s_waitcnt vmcnt(8)
    ds_read_b64_tr_b16 a[72:73], v4 offset:8192
    ds_read_b64_tr_b16 a[74:75], v4 offset:8704
    ds_read_b64_tr_b16 a[76:77], v5 offset:8192
    ds_read_b64_tr_b16 a[78:79], v5 offset:8704
    s_add_u32 m0, s81, 6144
    s_add_u32 s88, s49, 86016
    buffer_load_dwordx4 v2, s[28:31], s88 offen  lds
    buffer_load_dwordx4 v9, s[28:31], s88 offen offset:1024 lds
    s_add_u32 m0, s82, 2048
    s_add_u32 s88, s51, 14336
    buffer_load_dwordx4 v2, s[28:31], s88 offen  lds
    buffer_load_dwordx4 v9, s[28:31], s88 offen offset:1024 lds
    s_waitcnt vmcnt(10)
    ds_read_b64_tr_b16 a[80:81], v4 offset:0
    ds_read_b64_tr_b16 a[82:83], v4 offset:512
    ds_read_b64_tr_b16 a[84:85], v5 offset:0
    ds_read_b64_tr_b16 a[86:87], v5 offset:512
    s_waitcnt lgkmcnt(4)
    s_add_u32 m0, s81, 8192
    s_nop 0
    buffer_load_dwordx4 v2, s[28:31], s50 offen  lds
    buffer_load_dwordx4 v9, s[28:31], s50 offen offset:1024 lds
    s_add_u32 m0, s82, 4096
    s_add_u32 s88, s51, 28672
    buffer_load_dwordx4 v2, s[28:31], s88 offen  lds
    buffer_load_dwordx4 v9, s[28:31], s88 offen offset:1024 lds
    s_waitcnt vmcnt(12)
    ds_read_b64_tr_b16 a[88:89], v4 offset:2048
    ds_read_b64_tr_b16 a[90:91], v4 offset:2560
    ds_read_b64_tr_b16 a[92:93], v5 offset:2048
    ds_read_b64_tr_b16 a[94:95], v5 offset:2560
    s_waitcnt lgkmcnt(4)
    s_add_u32 m0, s81, 0
    s_add_u32 s88, s50, 14336
    buffer_load_dwordx4 v2, s[28:31], s88 offen  lds
    buffer_load_dwordx4 v9, s[28:31], s88 offen offset:1024 lds
    s_add_u32 m0, s82, 6144
    s_add_u32 s88, s51, 43008
    buffer_load_dwordx4 v2, s[28:31], s88 offen  lds
    buffer_load_dwordx4 v9, s[28:31], s88 offen offset:1024 lds
    s_waitcnt vmcnt(14)
    ds_read_b64_tr_b16 a[96:97], v4 offset:4096
    ds_read_b64_tr_b16 a[98:99], v4 offset:4608
    ds_read_b64_tr_b16 a[100:101], v5 offset:4096
    ds_read_b64_tr_b16 a[102:103], v5 offset:4608
    s_waitcnt lgkmcnt(4)
    s_add_u32 m0, s81, 2048
    s_add_u32 s88, s50, 28672
    buffer_load_dwordx4 v2, s[28:31], s88 offen  lds
    buffer_load_dwordx4 v9, s[28:31], s88 offen offset:1024 lds
    s_add_u32 m0, s82, 8192
    s_add_u32 s88, s51, 57344
    buffer_load_dwordx4 v2, s[28:31], s88 offen  lds
    buffer_load_dwordx4 v9, s[28:31], s88 offen offset:1024 lds
    s_waitcnt vmcnt(14)
    ds_read_b64_tr_b16 a[104:105], v4 offset:6144
    ds_read_b64_tr_b16 a[106:107], v4 offset:6656
    ds_read_b64_tr_b16 a[108:109], v5 offset:6144
    ds_read_b64_tr_b16 a[110:111], v5 offset:6656
    s_waitcnt lgkmcnt(4)
    s_add_u32 m0, s81, 4096
    s_add_u32 s88, s50, 43008
    buffer_load_dwordx4 v2, s[28:31], s88 offen  lds
    buffer_load_dwordx4 v9, s[28:31], s88 offen offset:1024 lds
    s_add_u32 m0, s82, 10240
    s_add_u32 s88, s51, 71680
    buffer_load_dwordx4 v2, s[28:31], s88 offen  lds
    buffer_load_dwordx4 v9, s[28:31], s88 offen offset:1024 lds
    s_waitcnt vmcnt(14)
    ds_read_b64_tr_b16 a[112:113], v4 offset:8192
    ds_read_b64_tr_b16 a[114:115], v4 offset:8704
    ds_read_b64_tr_b16 a[116:117], v5 offset:8192
    ds_read_b64_tr_b16 a[118:119], v5 offset:8704
    s_waitcnt lgkmcnt(4)
    s_add_u32 m0, s81, 6144
    s_add_u32 s88, s50, 57344
    buffer_load_dwordx4 v2, s[28:31], s88 offen  lds
    buffer_load_dwordx4 v9, s[28:31], s88 offen offset:1024 lds
    s_add_u32 m0, s82, 12288
    s_add_u32 s88, s51, 86016
    buffer_load_dwordx4 v2, s[28:31], s88 offen  lds
    buffer_load_dwordx4 v9, s[28:31], s88 offen offset:1024 lds
    s_waitcnt vmcnt(14)
    ds_read_b64_tr_b16 a[120:121], v4 offset:0
    ds_read_b64_tr_b16 a[122:123], v4 offset:512
    ds_read_b64_tr_b16 a[124:125], v5 offset:0
    ds_read_b64_tr_b16 a[126:127], v5 offset:512
    s_waitcnt lgkmcnt(4)
    s_add_u32 m0, s81, 8192
    s_add_u32 s88, s50, 71680
    buffer_load_dwordx4 v2, s[28:31], s88 offen  lds
    buffer_load_dwordx4 v9, s[28:31], s88 offen offset:1024 lds
    s_waitcnt lgkmcnt(0)
    s_add_u32 m0, s81, 0
    s_add_u32 s88, s50, 86016
    buffer_load_dwordx4 v2, s[28:31], s88 offen  lds
    buffer_load_dwordx4 v9, s[28:31], s88 offen offset:1024 lds
    v_lshrrev_b32 v112, 3, v1
    v_and_b32 v113, 7, v1
    v_lshlrev_b32 v15, 4, v113
    v_mul_u32_u24 v8, 896, v112
    v_add_u32 v8, v8, v15
    v_mul_u32_u24 v11, 272, v112
    v_lshl_add_u32 v11, v113, 5, v11
    s_mul_i32 s88, s66, 4352
    v_add_u32 v11, s88, v11
    v_add_u32 v12, 34816, v11
    v_and_b32 v114, 31, v1
    v_mul_u32_u24 v9, 272, v114
    v_lshrrev_b32 v114, 5, v1
    v_lshl_add_u32 v9, v114, 4, v9
    s_mul_i32 s88, s66, 17408
    v_add_u32 v9, s88, v9
    s_lshl_b32 s88, s79, 6
    s_lshl_b32 s88, s74, 1
    s_lshr_b32 s89, s66, 1
    s_add_u32 s88, s88, s89
    s_mul_i32 s88, s88, 28672
    s_and_b32 s89, s66, 1
    s_lshl_b32 s89, s89, 8
    s_add_u32 s88, s88, s89
    s_add_u32 s78, s88, 3145728
    s_mul_i32 s88, s83, 224
    s_add_u32 s92, s67, s88
    s_mul_i32 s88, s66, 14
    s_bfm_b64 s[96:97], 14, s88
    s_lshl_b32 s88, s74, 6
    s_lshl_b32 s89, s66, 4
    s_add_u32 s88, s88, s89
    s_mul_i32 s88, s88, 896
    s_lshl_b32 s89, s79, 7
    s_add_u32 s60, s88, s89
    s_add_u32 s61, s60, 7168
    s_lshl_b32 s62, s79, 7
    s_mov_b32 s93, 0xffff0000
    s_mov_b32 s99, 0
    s_branch L_sequential_preLN__linear_attn_block__dense_activation_gelu__prompt_kernel_29_f
L_sequential_preLN__linear_attn_block__dense_activation_gelu__prompt_kernel_29:
    s_sleep 1
L_sequential_preLN__linear_attn_block__dense_activation_gelu__prompt_kernel_29_f:
    buffer_load_dword v112, v3, s[44:47], s92 offen offset:1536 sc1
    s_waitcnt vmcnt(0)
L_sequential_preLN__linear_attn_block__dense_activation_gelu__prompt_kernel_29_c:
    s_add_u32 s99, s99, 1
    v_cmp_ne_u32 vcc, 0, v112
    s_nop 0
    s_andn2_b64 s[94:95], s[96:97], vcc
    s_cmp_eq_u64 s[94:95], 0
    s_cbranch_scc1 L_sequential_preLN__linear_attn_block__dense_activation_gelu__prompt_kernel_29_x
    s_cmp_lt_u32 s99, 32
    s_cbranch_scc1 L_sequential_preLN__linear_attn_block__dense_activation_gelu__prompt_kernel_29
L_sequential_preLN__linear_attn_block__dense_activation_gelu__prompt_kernel_29_s:
    buffer_load_dword v112, v3, s[44:47], s92 offen offset:1536 sc1
    buffer_load_dword v114, v3, s[44:47], s92 offen offset:3584 sc1
    s_add_u32 s99, s99, 1
    s_waitcnt vmcnt(0)
    v_or_b32 v112, v112, v114
    v_cmp_ne_u32 vcc, 0, v112
    s_nop 0
    s_andn2_b64 s[94:95], s[96:97], vcc
    s_cmp_eq_u64 s[94:95], 0
    s_cbranch_scc1 L_sequential_preLN__linear_attn_block__dense_activation_gelu__prompt_kernel_29_x
    s_cmp_lt_u32 s99, 200000
    s_cbranch_scc1 L_sequential_preLN__linear_attn_block__dense_activation_gelu__prompt_kernel_29_s
L_sequential_preLN__linear_attn_block__dense_activation_gelu__prompt_kernel_29_x:
    buffer_load_dwordx4 v[80:83], v10, s[44:47], s52 offen offset:0 sc1
    buffer_load_dwordx4 v[84:87], v10, s[44:47], s53 offen offset:0 sc1
    buffer_load_dwordx4 v[88:91], v10, s[44:47], s52 offen offset:1024 sc1
    buffer_load_dwordx4 v[92:95], v10, s[44:47], s53 offen offset:1024 sc1
    buffer_load_dwordx4 v[96:99], v10, s[44:47], s52 offen offset:2048 sc1
    buffer_load_dwordx4 v[100:103], v10, s[44:47], s53 offen offset:2048 sc1
    buffer_load_dwordx4 v[104:107], v10, s[44:47], s52 offen offset:3072 sc1
    buffer_load_dwordx4 v[108:111], v10, s[44:47], s53 offen offset:3072 sc1
    s_add_u32 s52, s52, 4096
    buffer_load_dwordx4 v[112:115], v10, s[44:47], s52 offen offset:0 sc1
    s_waitcnt vmcnt(8)
    v_mfma_f32_32x32x16_bf16 v[16:31], a[0:3], v[80:83], 0
    v_mfma_f32_32x32x16_bf16 v[32:47], a[4:7], v[80:83], 0
    s_add_u32 s53, s53, 4096
    buffer_load_dwordx4 v[116:119], v10, s[44:47], s53 offen offset:0 sc1
    s_waitcnt vmcnt(8)
    v_mfma_f32_32x32x16_bf16 v[48:63], a[0:3], v[84:87], 0
    v_mfma_f32_32x32x16_bf16 v[64:79], a[4:7], v[84:87], 0
    buffer_load_dwordx4 v[80:83], v10, s[44:47], s52 offen offset:1024 sc1
    s_waitcnt vmcnt(8)
    v_mfma_f32_32x32x16_bf16 v[16:31], a[8:11], v[88:91], v[16:31]
    v_mfma_f32_32x32x16_bf16 v[32:47], a[12:15], v[88:91], v[32:47]
    buffer_load_dwordx4 v[84:87], v10, s[44:47], s53 offen offset:1024 sc1
    s_waitcnt vmcnt(8)
    v_mfma_f32_32x32x16_bf16 v[48:63], a[8:11], v[92:95], v[48:63]
    v_mfma_f32_32x32x16_bf16 v[64:79], a[12:15], v[92:95], v[64:79]
    buffer_load_dwordx4 v[88:91], v10, s[44:47], s52 offen offset:2048 sc1
    ds_read_b64_tr_b16 a[0:1], v4 offset:2048
    ds_read_b64_tr_b16 a[2:3], v4 offset:2560
    ds_read_b64_tr_b16 a[4:5], v5 offset:2048
    ds_read_b64_tr_b16 a[6:7], v5 offset:2560
    s_waitcnt vmcnt(8)
    v_mfma_f32_32x32x16_bf16 v[16:31], a[16:19], v[96:99], v[16:31]
    v_mfma_f32_32x32x16_bf16 v[32:47], a[20:23], v[96:99], v[32:47]
    buffer_load_dwordx4 v[92:95], v10, s[44:47], s53 offen offset:2048 sc1
    s_waitcnt vmcnt(8)
    v_mfma_f32_32x32x16_bf16 v[48:63], a[16:19], v[100:103], v[48:63]
    v_mfma_f32_32x32x16_bf16 v[64:79], a[20:23], v[100:103], v[64:79]
    buffer_load_dwordx4 v[96:99], v10, s[44:47], s54 offen offset:0 sc1
    ds_read_b64_tr_b16 a[8:9], v4 offset:4096
    ds_read_b64_tr_b16 a[10:11], v4 offset:4608
    ds_read_b64_tr_b16 a[12:13], v5 offset:4096
    ds_read_b64_tr_b16 a[14:15], v5 offset:4608
    s_waitcnt vmcnt(8)
    v_mfma_f32_32x32x16_bf16 v[16:31], a[24:27], v[104:107], v[16:31]
    v_mfma_f32_32x32x16_bf16 v[32:47], a[28:31], v[104:107], v[32:47]
    buffer_load_dwordx4 v[100:103], v10, s[44:47], s55 offen offset:0 sc1
    s_waitcnt vmcnt(8)
    v_mfma_f32_32x32x16_bf16 v[48:63], a[24:27], v[108:111], v[48:63]
    v_mfma_f32_32x32x16_bf16 v[64:79], a[28:31], v[108:111], v[64:79]
    buffer_load_dwordx4 v[104:107], v10, s[44:47], s54 offen offset:1024 sc1
    ds_read_b64_tr_b16 a[16:17], v4 offset:6144
    ds_read_b64_tr_b16 a[18:19], v4 offset:6656
    ds_read_b64_tr_b16 a[20:21], v5 offset:6144
    ds_read_b64_tr_b16 a[22:23], v5 offset:6656
    s_waitcnt vmcnt(8)
    v_mfma_f32_32x32x16_bf16 v[16:31], a[32:35], v[112:115], v[16:31]
    v_mfma_f32_32x32x16_bf16 v[32:47], a[36:39], v[112:115], v[32:47]
    buffer_load_dwordx4 v[108:111], v10, s[44:47], s55 offen offset:1024 sc1
    s_waitcnt vmcnt(8)
    v_mfma_f32_32x32x16_bf16 v[48:63], a[32:35], v[116:119], v[48:63]
    v_mfma_f32_32x32x16_bf16 v[64:79], a[36:39], v[116:119], v[64:79]
    buffer_load_dwordx4 v[112:115], v10, s[44:47], s54 offen offset:2048 sc1
    ds_read_b64_tr_b16 a[24:25], v4 offset:8192
    ds_read_b64_tr_b16 a[26:27], v4 offset:8704
    ds_read_b64_tr_b16 a[28:29], v5 offset:8192
    ds_read_b64_tr_b16 a[30:31], v5 offset:8704
    s_waitcnt vmcnt(8)
    v_mfma_f32_32x32x16_bf16 v[16:31], a[40:43], v[80:83], v[16:31]
    v_mfma_f32_32x32x16_bf16 v[32:47], a[44:47], v[80:83], v[32:47]
    buffer_load_dwordx4 v[116:119], v10, s[44:47], s55 offen offset:2048 sc1
    s_waitcnt vmcnt(8)
    v_mfma_f32_32x32x16_bf16 v[48:63], a[40:43], v[84:87], v[48:63]
    v_mfma_f32_32x32x16_bf16 v[64:79], a[44:47], v[84:87], v[64:79]
    buffer_load_dwordx4 v[80:83], v10, s[44:47], s54 offen offset:3072 sc1
    ds_read_b64_tr_b16 a[32:33], v4 offset:0
    ds_read_b64_tr_b16 a[34:35], v4 offset:512
    ds_read_b64_tr_b16 a[36:37], v5 offset:0
    ds_read_b64_tr_b16 a[38:39], v5 offset:512
    s_waitcnt vmcnt(8)
    v_mfma_f32_32x32x16_bf16 v[16:31], a[48:51], v[88:91], v[16:31]
    v_mfma_f32_32x32x16_bf16 v[32:47], a[52:55], v[88:91], v[32:47]
    buffer_load_dwordx4 v[84:87], v10, s[44:47], s55 offen offset:3072 sc1
    s_waitcnt vmcnt(8)
    v_mfma_f32_32x32x16_bf16 v[48:63], a[48:51], v[92:95], v[48:63]
    v_mfma_f32_32x32x16_bf16 v[64:79], a[52:55], v[92:95], v[64:79]
    s_add_u32 s54, s54, 4096
    buffer_load_dwordx4 v[88:91], v10, s[44:47], s54 offen offset:0 sc1
    ds_read_b64_tr_b16 a[40:41], v6 offset:0
    ds_read_b64_tr_b16 a[42:43], v6 offset:512
    ds_read_b64_tr_b16 a[44:45], v7 offset:0
    ds_read_b64_tr_b16 a[46:47], v7 offset:512
    s_waitcnt vmcnt(8)
    v_mfma_f32_32x32x16_bf16 v[16:31], a[56:59], v[96:99], v[16:31]
    v_mfma_f32_32x32x16_bf16 v[32:47], a[60:63], v[96:99], v[32:47]
    s_add_u32 s55, s55, 4096
    buffer_load_dwordx4 v[92:95], v10, s[44:47], s55 offen offset:0 sc1
    s_waitcnt vmcnt(8)
    v_mfma_f32_32x32x16_bf16 v[48:63], a[56:59], v[100:103], v[48:63]
    v_mfma_f32_32x32x16_bf16 v[64:79], a[60:63], v[100:103], v[64:79]
    buffer_load_dwordx4 v[96:99], v10, s[44:47], s54 offen offset:1024 sc1
    ds_read_b64_tr_b16 a[48:49], v6 offset:2048
    ds_read_b64_tr_b16 a[50:51], v6 offset:2560
    ds_read_b64_tr_b16 a[52:53], v7 offset:2048
    ds_read_b64_tr_b16 a[54:55], v7 offset:2560
    s_waitcnt vmcnt(8)
    v_mfma_f32_32x32x16_bf16 v[16:31], a[64:67], v[104:107], v[16:31]
    v_mfma_f32_32x32x16_bf16 v[32:47], a[68:71], v[104:107], v[32:47]
    buffer_load_dwordx4 v[100:103], v10, s[44:47], s55 offen offset:1024 sc1
    s_waitcnt vmcnt(8)
    v_mfma_f32_32x32x16_bf16 v[48:63], a[64:67], v[108:111], v[48:63]
    v_mfma_f32_32x32x16_bf16 v[64:79], a[68:71], v[108:111], v[64:79]
    buffer_load_dwordx4 v[104:107], v10, s[44:47], s54 offen offset:2048 sc1
    ds_read_b64_tr_b16 a[56:57], v6 offset:4096
    ds_read_b64_tr_b16 a[58:59], v6 offset:4608
    ds_read_b64_tr_b16 a[60:61], v7 offset:4096
    ds_read_b64_tr_b16 a[62:63], v7 offset:4608
    s_waitcnt vmcnt(8)
    v_mfma_f32_32x32x16_bf16 v[16:31], a[72:75], v[112:115], v[16:31]
    v_mfma_f32_32x32x16_bf16 v[32:47], a[76:79], v[112:115], v[32:47]
    buffer_load_dwordx4 v[108:111], v10, s[44:47], s55 offen offset:2048 sc1
    s_waitcnt vmcnt(8)
    v_mfma_f32_32x32x16_bf16 v[48:63], a[72:75], v[116:119], v[48:63]
    v_mfma_f32_32x32x16_bf16 v[64:79], a[76:79], v[116:119], v[64:79]
    buffer_load_dwordx4 v[112:115], v10, s[44:47], s56 offen offset:0 sc1
    ds_read_b64_tr_b16 a[64:65], v6 offset:6144
    ds_read_b64_tr_b16 a[66:67], v6 offset:6656
    ds_read_b64_tr_b16 a[68:69], v7 offset:6144
    ds_read_b64_tr_b16 a[70:71], v7 offset:6656
    s_waitcnt vmcnt(8)
    v_mfma_f32_32x32x16_bf16 v[16:31], a[80:83], v[80:83], v[16:31]
    v_mfma_f32_32x32x16_bf16 v[32:47], a[84:87], v[80:83], v[32:47]
    buffer_load_dwordx4 v[116:119], v10, s[44:47], s57 offen offset:0 sc1
    s_waitcnt vmcnt(8)
    v_mfma_f32_32x32x16_bf16 v[48:63], a[80:83], v[84:87], v[48:63]
    v_mfma_f32_32x32x16_bf16 v[64:79], a[84:87], v[84:87], v[64:79]
    buffer_load_dwordx4 v[80:83], v10, s[44:47], s56 offen offset:1024 sc1
    ds_read_b64_tr_b16 a[72:73], v6 offset:8192
    ds_read_b64_tr_b16 a[74:75], v6 offset:8704
    ds_read_b64_tr_b16 a[76:77], v7 offset:8192
    ds_read_b64_tr_b16 a[78:79], v7 offset:8704
    s_waitcnt vmcnt(8)
    v_mfma_f32_32x32x16_bf16 v[16:31], a[88:91], v[88:91], v[16:31]
    v_mfma_f32_32x32x16_bf16 v[32:47], a[92:95], v[88:91], v[32:47]
    buffer_load_dwordx4 v[84:87], v10, s[44:47], s57 offen offset:1024 sc1
    s_waitcnt vmcnt(8)
    v_mfma_f32_32x32x16_bf16 v[48:63], a[88:91], v[92:95], v[48:63]
    v_mfma_f32_32x32x16_bf16 v[64:79], a[92:95], v[92:95], v[64:79]
    buffer_load_dwordx4 v[88:91], v10, s[44:47], s56 offen offset:2048 sc1
    ds_read_b64_tr_b16 a[80:81], v6 offset:10240
    ds_read_b64_tr_b16 a[82:83], v6 offset:10752
    ds_read_b64_tr_b16 a[84:85], v7 offset:10240
    ds_read_b64_tr_b16 a[86:87], v7 offset:10752
    s_waitcnt vmcnt(8)
    v_mfma_f32_32x32x16_bf16 v[16:31], a[96:99], v[96:99], v[16:31]
    v_mfma_f32_32x32x16_bf16 v[32:47], a[100:103], v[96:99], v[32:47]
    buffer_load_dwordx4 v[92:95], v10, s[44:47], s57 offen offset:2048 sc1
    s_waitcnt vmcnt(8)
    v_mfma_f32_32x32x16_bf16 v[48:63], a[96:99], v[100:103], v[48:63]
    v_mfma_f32_32x32x16_bf16 v[64:79], a[100:103], v[100:103], v[64:79]
    buffer_load_dwordx4 v[96:99], v10, s[44:47], s56 offen offset:3072 sc1
    ds_read_b64_tr_b16 a[88:89], v6 offset:12288
    ds_read_b64_tr_b16 a[90:91], v6 offset:12800
    ds_read_b64_tr_b16 a[92:93], v7 offset:12288
    ds_read_b64_tr_b16 a[94:95], v7 offset:12800
    s_waitcnt vmcnt(8)
    v_mfma_f32_32x32x16_bf16 v[16:31], a[104:107], v[104:107], v[16:31]
    v_mfma_f32_32x32x16_bf16 v[32:47], a[108:111], v[104:107], v[32:47]
    buffer_load_dwordx4 v[100:103], v10, s[44:47], s57 offen offset:3072 sc1
    s_waitcnt vmcnt(8)
    v_mfma_f32_32x32x16_bf16 v[48:63], a[104:107], v[108:111], v[48:63]
    v_mfma_f32_32x32x16_bf16 v[64:79], a[108:111], v[108:111], v[64:79]
    s_add_u32 s56, s56, 4096
    buffer_load_dwordx4 v[104:107], v10, s[44:47], s56 offen offset:0 sc1
    s_waitcnt vmcnt(8)
    v_mfma_f32_32x32x16_bf16 v[16:31], a[112:115], v[112:115], v[16:31]
    v_mfma_f32_32x32x16_bf16 v[32:47], a[116:119], v[112:115], v[32:47]
    s_add_u32 s57, s57, 4096
    buffer_load_dwordx4 v[108:111], v10, s[44:47], s57 offen offset:0 sc1
    s_waitcnt vmcnt(8)
    v_mfma_f32_32x32x16_bf16 v[48:63], a[112:115], v[116:119], v[48:63]
    v_mfma_f32_32x32x16_bf16 v[64:79], a[116:119], v[116:119], v[64:79]
    buffer_load_dwordx4 v[112:115], v10, s[44:47], s56 offen offset:1024 sc1
    s_waitcnt vmcnt(8)
    v_mfma_f32_32x32x16_bf16 v[16:31], a[120:123], v[80:83], v[16:31]
    v_mfma_f32_32x32x16_bf16 v[32:47], a[124:127], v[80:83], v[32:47]
    buffer_load_dwordx4 v[116:119], v10, s[44:47], s57 offen offset:1024 sc1
    s_waitcnt vmcnt(8)
    v_mfma_f32_32x32x16_bf16 v[48:63], a[120:123], v[84:87], v[48:63]
    v_mfma_f32_32x32x16_bf16 v[64:79], a[124:127], v[84:87], v[64:79]
    buffer_load_dwordx4 v[80:83], v10, s[44:47], s56 offen offset:2048 sc1
    s_waitcnt lgkmcnt(15)
    s_waitcnt vmcnt(8)
    v_mfma_f32_32x32x16_bf16 v[16:31], a[0:3], v[88:91], v[16:31]
    v_mfma_f32_32x32x16_bf16 v[32:47], a[4:7], v[88:91], v[32:47]
    buffer_load_dwordx4 v[84:87], v10, s[44:47], s57 offen offset:2048 sc1
    s_waitcnt vmcnt(8)
    v_mfma_f32_32x32x16_bf16 v[48:63], a[0:3], v[92:95], v[48:63]
    v_mfma_f32_32x32x16_bf16 v[64:79], a[4:7], v[92:95], v[64:79]
    buffer_load_dwordx4 v[88:91], v10, s[44:47], s58 offen offset:0 sc1
    s_waitcnt vmcnt(8)
    v_mfma_f32_32x32x16_bf16 v[16:31], a[8:11], v[96:99], v[16:31]
    v_mfma_f32_32x32x16_bf16 v[32:47], a[12:15], v[96:99], v[32:47]
    buffer_load_dwordx4 v[92:95], v10, s[44:47], s59 offen offset:0 sc1
    s_waitcnt vmcnt(8)
    v_mfma_f32_32x32x16_bf16 v[48:63], a[8:11], v[100:103], v[48:63]
    v_mfma_f32_32x32x16_bf16 v[64:79], a[12:15], v[100:103], v[64:79]
    buffer_load_dwordx4 v[96:99], v10, s[44:47], s58 offen offset:1024 sc1
    s_waitcnt vmcnt(8)
    v_mfma_f32_32x32x16_bf16 v[16:31], a[16:19], v[104:107], v[16:31]
    v_mfma_f32_32x32x16_bf16 v[32:47], a[20:23], v[104:107], v[32:47]
    buffer_load_dwordx4 v[100:103], v10, s[44:47], s58 offen offset:2048 sc1
    s_waitcnt vmcnt(8)
    v_mfma_f32_32x32x16_bf16 v[48:63], a[16:19], v[108:111], v[48:63]
    v_mfma_f32_32x32x16_bf16 v[64:79], a[20:23], v[108:111], v[64:79]
    buffer_load_dwordx4 v[104:107], v10, s[44:47], s58 offen offset:3072 sc1
    s_waitcnt vmcnt(8)
    v_mfma_f32_32x32x16_bf16 v[16:31], a[24:27], v[112:115], v[16:31]
    v_mfma_f32_32x32x16_bf16 v[32:47], a[28:31], v[112:115], v[32:47]
    s_add_u32 s58, s58, 4096
    buffer_load_dwordx4 v[108:111], v10, s[44:47], s58 offen offset:0 sc1
    s_waitcnt vmcnt(8)
    v_mfma_f32_32x32x16_bf16 v[48:63], a[24:27], v[116:119], v[48:63]
    v_mfma_f32_32x32x16_bf16 v[64:79], a[28:31], v[116:119], v[64:79]
    buffer_load_dwordx4 v[112:115], v10, s[44:47], s58 offen offset:1024 sc1
    s_waitcnt vmcnt(8)
    v_mfma_f32_32x32x16_bf16 v[16:31], a[32:35], v[80:83], v[16:31]
    v_mfma_f32_32x32x16_bf16 v[32:47], a[36:39], v[80:83], v[32:47]
    buffer_load_dwordx4 v[116:119], v10, s[44:47], s58 offen offset:2048 sc1
    s_waitcnt vmcnt(8)
    v_mfma_f32_32x32x16_bf16 v[48:63], a[32:35], v[84:87], v[48:63]
    v_mfma_f32_32x32x16_bf16 v[64:79], a[36:39], v[84:87], v[64:79]
    buffer_load_dwordx4 v[80:83], v10, s[44:47], s59 offen offset:1024 sc1
    s_waitcnt vmcnt(8)
    v_mfma_f32_32x32x16_bf16 v[16:31], a[40:43], v[88:91], v[16:31]
    v_mfma_f32_32x32x16_bf16 v[32:47], a[44:47], v[88:91], v[32:47]
    buffer_load_dwordx4 v[84:87], v10, s[44:47], s59 offen offset:2048 sc1
    s_waitcnt vmcnt(8)
    v_mfma_f32_32x32x16_bf16 v[48:63], a[40:43], v[92:95], v[48:63]
    v_mfma_f32_32x32x16_bf16 v[64:79], a[44:47], v[92:95], v[64:79]
    buffer_load_dwordx4 v[88:91], v10, s[44:47], s59 offen offset:3072 sc1
    s_waitcnt vmcnt(8)
    v_mfma_f32_32x32x16_bf16 v[16:31], a[48:51], v[96:99], v[16:31]
    v_mfma_f32_32x32x16_bf16 v[32:47], a[52:55], v[96:99], v[32:47]
    s_add_u32 s59, s59, 4096
    buffer_load_dwordx4 v[92:95], v10, s[44:47], s59 offen offset:0 sc1
    s_waitcnt vmcnt(8)
    v_mfma_f32_32x32x16_bf16 v[16:31], a[56:59], v[100:103], v[16:31]
    v_mfma_f32_32x32x16_bf16 v[32:47], a[60:63], v[100:103], v[32:47]
    buffer_load_dwordx4 v[96:99], v10, s[44:47], s59 offen offset:1024 sc1
    s_waitcnt lgkmcnt(12)
    s_waitcnt vmcnt(8)
    v_mfma_f32_32x32x16_bf16 v[16:31], a[64:67], v[104:107], v[16:31]
    v_mfma_f32_32x32x16_bf16 v[32:47], a[68:71], v[104:107], v[32:47]
    buffer_load_dwordx4 v[100:103], v10, s[44:47], s59 offen offset:2048 sc1
    s_waitcnt lgkmcnt(8)
    s_waitcnt vmcnt(8)
    v_mfma_f32_32x32x16_bf16 v[16:31], a[72:75], v[108:111], v[16:31]
    v_mfma_f32_32x32x16_bf16 v[32:47], a[76:79], v[108:111], v[32:47]
    s_waitcnt lgkmcnt(4)
    s_waitcnt vmcnt(7)
    v_mfma_f32_32x32x16_bf16 v[16:31], a[80:83], v[112:115], v[16:31]
    v_mfma_f32_32x32x16_bf16 v[32:47], a[84:87], v[112:115], v[32:47]
    s_waitcnt lgkmcnt(0)
    s_barrier
    s_waitcnt vmcnt(6)
    v_mfma_f32_32x32x16_bf16 v[16:31], a[88:91], v[116:119], v[16:31]
    v_mfma_f32_32x32x16_bf16 v[32:47], a[92:95], v[116:119], v[32:47]
    s_waitcnt vmcnt(5)
    v_mfma_f32_32x32x16_bf16 v[48:63], a[48:51], v[80:83], v[48:63]
    v_mfma_f32_32x32x16_bf16 v[64:79], a[52:55], v[80:83], v[64:79]
    buffer_load_dwordx4 v[112:115], v15, s[32:35], s62 offen
    s_waitcnt vmcnt(5)
    v_mfma_f32_32x32x16_bf16 v[48:63], a[56:59], v[84:87], v[48:63]
    s_nop 4
    ds_write_b128 v9, v[16:19] offset:0
    v_mfma_f32_32x32x16_bf16 v[64:79], a[60:63], v[84:87], v[64:79]
    ds_write_b128 v9, v[20:23] offset:32
    s_waitcnt vmcnt(4)
    v_mfma_f32_32x32x16_bf16 v[48:63], a[64:67], v[88:91], v[48:63]
    ds_write_b128 v9, v[24:27] offset:64
    v_mfma_f32_32x32x16_bf16 v[64:79], a[68:71], v[88:91], v[64:79]
    ds_write_b128 v9, v[28:31] offset:96
    s_waitcnt vmcnt(3)
    v_mfma_f32_32x32x16_bf16 v[48:63], a[72:75], v[92:95], v[48:63]
    ds_write_b128 v9, v[32:35] offset:128
    v_mfma_f32_32x32x16_bf16 v[64:79], a[76:79], v[92:95], v[64:79]
    ds_write_b128 v9, v[36:39] offset:160
    s_waitcnt vmcnt(2)
    v_mfma_f32_32x32x16_bf16 v[48:63], a[80:83], v[96:99], v[48:63]
    ds_write_b128 v9, v[40:43] offset:192
    v_mfma_f32_32x32x16_bf16 v[64:79], a[84:87], v[96:99], v[64:79]
    ds_write_b128 v9, v[44:47] offset:224
    s_waitcnt vmcnt(1)
    v_mfma_f32_32x32x16_bf16 v[48:63], a[88:91], v[100:103], v[48:63]
    v_mfma_f32_32x32x16_bf16 v[64:79], a[92:95], v[100:103], v[64:79]
    s_nop 10
    ds_write_b128 v9, v[48:51] offset:8704
    ds_write_b128 v9, v[52:55] offset:8736
    ds_write_b128 v9, v[56:59] offset:8768
    ds_write_b128 v9, v[60:63] offset:8800
    ds_write_b128 v9, v[64:67] offset:8832
    ds_write_b128 v9, v[68:71] offset:8864
    ds_write_b128 v9, v[72:75] offset:8896
    ds_write_b128 v9, v[76:79] offset:8928
    s_waitcnt vmcnt(0)
    v_lshlrev_b32 v80, 16, v112
    v_and_b32 v81, s93, v112
    v_lshlrev_b32 v82, 16, v113
    v_and_b32 v83, s93, v113
    v_lshlrev_b32 v84, 16, v114
    v_and_b32 v85, s93, v114
    v_lshlrev_b32 v86, 16, v115
    v_and_b32 v87, s93, v115
    v_lshlrev_b32 v88, 16, v120
    v_and_b32 v89, s93, v120
    v_lshlrev_b32 v90, 16, v121
    v_and_b32 v91, s93, v121
    v_lshlrev_b32 v92, 16, v122
    v_and_b32 v93, s93, v122
    v_lshlrev_b32 v94, 16, v123
    v_and_b32 v95, s93, v123
    v_add_f32 v88, v88, v80
    v_add_f32 v89, v89, v81
    v_add_f32 v90, v90, v82
    v_add_f32 v91, v91, v83
    v_add_f32 v92, v92, v84
    v_add_f32 v93, v93, v85
    v_add_f32 v94, v94, v86
    v_add_f32 v95, v95, v87
    v_lshlrev_b32 v96, 16, v124
    v_and_b32 v97, s93, v124
    v_lshlrev_b32 v98, 16, v125
    v_and_b32 v99, s93, v125
    v_lshlrev_b32 v100, 16, v126
    v_and_b32 v101, s93, v126
    v_lshlrev_b32 v102, 16, v127
    v_and_b32 v103, s93, v127
    v_add_f32 v96, v96, v80
    v_add_f32 v97, v97, v81
    v_add_f32 v98, v98, v82
    v_add_f32 v99, v99, v83
    v_add_f32 v100, v100, v84
    v_add_f32 v101, v101, v85
    v_add_f32 v102, v102, v86
    v_add_f32 v103, v103, v87
    s_waitcnt lgkmcnt(0)
    s_barrier
    ds_read_b128 v[16:19], v11 offset:0
    ds_read_b128 v[20:23], v11 offset:16
    ds_read_b128 v[24:27], v11 offset:17408
    ds_read_b128 v[28:31], v11 offset:17424
    ds_read_b128 v[32:35], v12 offset:0
    ds_read_b128 v[36:39], v12 offset:16
    ds_read_b128 v[40:43], v12 offset:17408
    ds_read_b128 v[44:47], v12 offset:17424
    ds_read_b128 v[48:51], v11 offset:2176
    ds_read_b128 v[52:55], v11 offset:2192
    ds_read_b128 v[56:59], v11 offset:19584
    ds_read_b128 v[60:63], v11 offset:19600
    ds_read_b128 v[64:67], v12 offset:2176
    ds_read_b128 v[68:71], v12 offset:2192
    ds_read_b128 v[72:75], v12 offset:19584
    ds_read_b128 v[76:79], v12 offset:19600
    s_waitcnt lgkmcnt(8)
    v_add_f32 v16, v16, v24
    v_add_f32 v32, v32, v40
    v_add_f32 v17, v17, v25
    v_add_f32 v33, v33, v41
    v_add_f32 v18, v18, v26
    v_add_f32 v34, v34, v42
    v_add_f32 v19, v19, v27
    v_add_f32 v35, v35, v43
    v_add_f32 v20, v20, v28
    v_add_f32 v36, v36, v44
    v_add_f32 v21, v21, v29
    v_add_f32 v37, v37, v45
    v_add_f32 v22, v22, v30
    v_add_f32 v38, v38, v46
    v_add_f32 v23, v23, v31
    v_add_f32 v39, v39, v47
    v_add_f32 v16, v16, v88
    v_add_f32 v17, v17, v89
    v_add_f32 v18, v18, v90
    v_add_f32 v19, v19, v91
    v_add_f32 v20, v20, v92
    v_add_f32 v21, v21, v93
    v_add_f32 v22, v22, v94
    v_add_f32 v23, v23, v95
    v_add_f32 v16, v16, v32
    v_add_f32 v17, v17, v33
    v_add_f32 v18, v18, v34
    v_add_f32 v19, v19, v35
    v_add_f32 v20, v20, v36
    v_add_f32 v21, v21, v37
    v_add_f32 v22, v22, v38
    v_add_f32 v23, v23, v39
    v_cvt_pk_bf16_f32 v32, v16, v17
    v_cvt_pk_bf16_f32 v33, v18, v19
    v_cvt_pk_bf16_f32 v34, v20, v21
    v_cvt_pk_bf16_f32 v35, v22, v23
    buffer_store_dwordx4 v[32:35], v8, s[36:39], s60 offen
    s_waitcnt lgkmcnt(0)
    v_add_f32 v48, v48, v56
    v_add_f32 v64, v64, v72
    v_add_f32 v49, v49, v57
    v_add_f32 v65, v65, v73
    v_add_f32 v50, v50, v58
    v_add_f32 v66, v66, v74
    v_add_f32 v51, v51, v59
    v_add_f32 v67, v67, v75
    v_add_f32 v52, v52, v60
    v_add_f32 v68, v68, v76
    v_add_f32 v53, v53, v61
    v_add_f32 v69, v69, v77
    v_add_f32 v54, v54, v62
    v_add_f32 v70, v70, v78
    v_add_f32 v55, v55, v63
    v_add_f32 v71, v71, v79
    v_add_f32 v48, v48, v96
    v_add_f32 v49, v49, v97
    v_add_f32 v50, v50, v98
    v_add_f32 v51, v51, v99
    v_add_f32 v52, v52, v100
    v_add_f32 v53, v53, v101
    v_add_f32 v54, v54, v102
    v_add_f32 v55, v55, v103
    v_add_f32 v48, v48, v64
    v_add_f32 v49, v49, v65
    v_add_f32 v50, v50, v66
    v_add_f32 v51, v51, v67
    v_add_f32 v52, v52, v68
    v_add_f32 v53, v53, v69
    v_add_f32 v54, v54, v70
    v_add_f32 v55, v55, v71
    v_cvt_pk_bf16_f32 v64, v48, v49
    v_cvt_pk_bf16_f32 v65, v50, v51
    v_cvt_pk_bf16_f32 v66, v52, v53
    v_cvt_pk_bf16_f32 v67, v54, v55
    buffer_store_dwordx4 v[64:67], v8, s[36:39], s61 offen
LgbendY_sequential_preLN__linear_attn_block__dense_activation_gelu__prompt_kernel:
    s_endpgm
LprogX_sequential_preLN__linear_attn_block__dense_activation_gelu__prompt_kernel:
    s_and_b32 s74, s65, 15
    s_lshr_b32 s75, s65, 4
    s_lshl_b32 s88, s64, 1
    s_add_u32 s75, s75, s88
    s_mul_i32 s77, s66, 24576
    s_add_u32 s77, s77, 57344
    v_lshlrev_b32 v5, 7, v1
    s_mov_b32 s80, 1329540880
    s_mov_b32 s81, 2566387445
    s_lshl_b32 s88, s74, 2
    s_lshr_b64 s[80:81], s[80:81], s88
    s_and_b32 s81, s80, 15
    s_lshr_b32 s88, s65, 4
    s_mul_i32 s88, s88, 10
    s_add_u32 s80, s81, s88
    s_lshl_b32 s80, s80, 13
    s_mul_i32 s88, s66, 163840
    s_add_u32 s82, s80, s88
    s_mul_i32 s88, s81, 21846
    s_lshr_b32 s88, s88, 16
    s_mul_i32 s88, s88, 3
    s_sub_u32 s83, s81, s88
    s_cmp_eq_u32 s81, 15
    s_cselect_b32 s83, 99, s83
    s_cmp_lg_u32 s66, 2
    s_cbranch_scc1 L_sequential_preLN__linear_attn_block__dense_activation_gelu__prompt_kernel_30
    s_mul_i32 s88, s65, 1280
    v_add_u32 v6, s88, v5
    v_cmp_gt_u32 vcc, 10, v1
    v_cmp_gt_u32 s[92:93], s3, v6
    s_nop 0
    s_and_b64 exec, vcc, s[92:93]
    s_cbranch_execz L_sequential_preLN__linear_attn_block__dense_activation_gelu__prompt_kernel_30_r
    global_load_dword v127, v6, s[78:79]
L_sequential_preLN__linear_attn_block__dense_activation_gelu__prompt_kernel_30_r:
    s_mov_b64 exec, -1
L_sequential_preLN__linear_attn_block__dense_activation_gelu__prompt_kernel_30:
    s_waitcnt lgkmcnt(0)
    s_mov_b32 s44, s72
    s_mov_b32 s45, s73
    s_mov_b32 s46, 268435456
    s_mov_b32 s47, 0x00020000
    s_mov_b32 s40, s86
    s_mov_b32 s41, s87
    s_mov_b32 s42, 256
    s_mov_b32 s43, 0x00020000
    s_mov_b32 s16, s52
    s_mov_b32 s17, s53
    s_mov_b32 s18, 401408
    s_mov_b32 s19, 0x00020000
    s_mov_b32 s20, s56
    s_mov_b32 s21, s57
    s_mov_b32 s22, 1605632
    s_mov_b32 s23, 0x00020000
    s_mov_b32 s24, s58
    s_mov_b32 s25, s59
    s_mov_b32 s26, 3584
    s_mov_b32 s27, 0x00020000
    s_mov_b32 s28, s60
    s_mov_b32 s29, s61
    s_mov_b32 s30, 1605632
    s_mov_b32 s31, 0x00020000
    s_mov_b32 s32, s62
    s_mov_b32 s33, s63
    s_mov_b32 s34, 896
    s_mov_b32 s35, 0x00020000
    s_mov_b32 s36, s84
    s_mov_b32 s37, s85
    s_mov_b32 s38, 1835008
    s_mov_b32 s39, 0x00020000
    s_mov_b32 s4, s72
    s_mov_b32 s5, s73
    s_mov_b32 s6, 268435456
    s_mov_b32 s7, 0x00020000
    s_mov_b32 s68, s72
    s_mov_b32 s69, s73
    s_mov_b32 s70, 0
    s_mov_b32 s71, 0x00020000
    s_lshl_b32 s67, s64, 12
    s_add_u32 s67, s67, 65536
    s_cmp_lg_u32 s66, 3
    s_cbranch_scc1 L_sequential_preLN__linear_attn_block__dense_activation_gelu__prompt_kernel_31
    v_lshlrev_b32 v8, 4, v1
    v_mov_b32 v12, 0
    v_mov_b32 v13, 0
    v_mov_b32 v14, 0
    v_mov_b32 v15, 0
    v_add_u32 v9, 163712, v8
    s_mov_b64 exec, 0xff
    ds_write_b128 v9, v[12:15]
    s_mov_b64 exec, -1
    s_cmp_lg_u32 s65, 31
    s_cbranch_scc1 L_sequential_preLN__linear_attn_block__dense_activation_gelu__prompt_kernel_31_w
    s_lshl_b32 s88, s64, 13
    s_add_u32 s89, s88, 4096
    buffer_store_dwordx4 v[12:15], v8, s[44:47], s67 offen offset:0 sc1
    buffer_store_dwordx4 v[12:15], v8, s[44:47], s67 offen offset:1024 sc1
    buffer_store_dwordx4 v[12:15], v8, s[44:47], s67 offen offset:2048 sc1
    buffer_store_dwordx4 v[12:15], v8, s[44:47], s67 offen offset:3072 sc1
    buffer_store_dwordx4 v[12:15], v8, s[44:47], s88 offen offset:0 sc1
    buffer_store_dwordx4 v[12:15], v8, s[44:47], s88 offen offset:1024 sc1
    buffer_store_dwordx4 v[12:15], v8, s[44:47], s88 offen offset:2048 sc1
    buffer_store_dwordx4 v[12:15], v8, s[44:47], s88 offen offset:3072 sc1
    buffer_store_dwordx4 v[12:15], v8, s[44:47], s89 offen offset:0 sc1
    buffer_store_dwordx4 v[12:15], v8, s[44:47], s89 offen offset:1024 sc1
    buffer_store_dwordx4 v[12:15], v8, s[44:47], s89 offen offset:2048 sc1
    buffer_store_dwordx4 v[12:15], v8, s[44:47], s89 offen offset:3072 sc1
    s_lshl_b32 s89, s64, 10
    s_add_u32 s89, s89, 102400
    buffer_store_dwordx4 v[12:15], v8, s[44:47], s89 offen sc1
    s_lshl_b32 s89, s64, 7
    s_add_u32 s89, s89, 98304
    s_mov_b64 exec, 0xff
    buffer_store_dwordx4 v[12:15], v8, s[44:47], s89 offen sc1
    s_lshl_b32 s89, s64, 5
    s_nop 0
    v_mov_b32 v13, 1
    s_mov_b64 exec, 1
    s_waitcnt vmcnt(0)
    buffer_store_dword v13, v12, s[40:43], s89 offen sc1
    s_mov_b64 exec, -1
L_sequential_preLN__linear_attn_block__dense_activation_gelu__prompt_kernel_31_w:
    s_waitcnt lgkmcnt(0)
L_sequential_preLN__linear_attn_block__dense_activation_gelu__prompt_kernel_31:
    v_and_b32 v14, 31, v1
    v_lshlrev_b32 v14, 7, v14
    v_add_u32 v14, s77, v14
    v_bfe_u32 v12, v1, 1, 3
    v_lshrrev_b32 v13, 5, v1
    v_xor_b32 v12, v12, v13
    v_xor_b32 v13, 0, v12
    v_lshl_add_u32 v6, v13, 4, v14
    v_xor_b32 v13, 2, v12
    v_lshl_add_u32 v7, v13, 4, v14
    v_xor_b32 v13, 4, v12
    v_lshl_add_u32 v8, v13, 4, v14
    v_xor_b32 v13, 6, v12
    v_lshl_add_u32 v9, v13, 4, v14
    s_and_b32 s88, s74, 1
    s_lshl_b32 s88, s88, 3
    v_lshrrev_b32 v14, 5, v1
    v_bfe_u32 v15, v1, 2, 2
    v_lshl_add_u32 v14, v14, 3, v15
    v_lshlrev_b32 v10, 7, v14
    v_bfe_u32 v15, v1, 3, 1
    v_lshl_add_u32 v10, v15, 6, v10
    v_bfe_u32 v15, v1, 4, 1
    v_lshl_add_u32 v10, v15, 5, v10
    v_and_b32 v13, 3, v1
    v_lshl_add_u32 v10, v13, 3, v10
    v_xor_b32 v11, 64, v10
    v_and_b32 v13, 0x13, v1
    v_cmp_eq_u32 vcc, 0x13, v13
    s_nop 1
    v_cndmask_b32 v13, 0, -8, vcc
    v_add_u32 v13, s88, v13
    v_add_u32 v10, v13, v10
    v_add_u32 v11, v13, v11
    v_lshlrev_b32 v12, 6, v14
    v_lshl_add_u32 v12, v15, 5, v12
    v_add_u32 v12, v13, v12
    v_and_b32 v13, 1, v1
    v_lshl_add_u32 v12, v13, 4, v12
    v_bfe_u32 v13, v1, 1, 1
    v_lshl_add_u32 v12, v13, 3, v12
    v_add_u32 v12, 110592, v12
    v_and_b32 v4, 7, v1
    v_lshlrev_b32 v4, 5, v4
    v_lshrrev_b32 v112, 4, v1
    v_xor_b32 v112, v112, v1
    v_and_b32 v112, 1, v112
    v_cmp_eq_u32 vcc, 0, v112
    v_mov_b32 v112, 0x3f803f80
    s_nop 0
    v_cndmask_b32 v80, 0, v112, vcc
    v_cndmask_b32 v81, 0, v112, vcc
    v_cndmask_b32 v82, 0, v112, vcc
    v_cndmask_b32 v83, 0, v112, vcc
    s_barrier
    ds_read_b128 a[0:3], v6 offset:0
    ds_read_b64_tr_b16 v[48:49], v10 offset:0
    ds_read_b64_tr_b16 v[50:51], v10 offset:512
    ds_read_b64_tr_b16 v[52:53], v11 offset:0
    ds_read_b64_tr_b16 v[54:55], v11 offset:512
    ds_read_b128 a[4:7], v7 offset:0
    ds_read_b64_tr_b16 v[56:57], v10 offset:2048
    ds_read_b64_tr_b16 v[58:59], v10 offset:2560
    ds_read_b64_tr_b16 v[60:61], v11 offset:2048
    ds_read_b64_tr_b16 v[62:63], v11 offset:2560
    s_waitcnt lgkmcnt(5)
    v_mfma_f32_32x32x16_bf16 v[16:31], a[0:3], v[48:51], 0
    ds_read_b128 a[8:11], v8 offset:0
    ds_read_b64_tr_b16 v[64:65], v10 offset:4096
    v_mfma_f32_32x32x16_bf16 v[32:47], a[0:3], v[52:55], 0
    ds_read_b64_tr_b16 v[66:67], v10 offset:4608
    ds_read_b64_tr_b16 v[68:69], v11 offset:4096
    v_mfma_f32_32x32x16_bf16 v[96:111], a[0:3], a[0:3], 0
    ds_read_b64_tr_b16 v[70:71], v11 offset:4608
    v_mfma_f32_16x16x32_bf16 v[84:87], v[80:83], a[0:3], 0
    s_waitcnt lgkmcnt(5)
    v_mfma_f32_32x32x16_bf16 v[16:31], a[4:7], v[56:59], v[16:31]
    ds_read_b128 a[12:15], v9 offset:0
    ds_read_b64_tr_b16 v[72:73], v10 offset:6144
    v_mfma_f32_32x32x16_bf16 v[32:47], a[4:7], v[60:63], v[32:47]
    ds_read_b64_tr_b16 v[74:75], v10 offset:6656
    ds_read_b64_tr_b16 v[76:77], v11 offset:6144
    v_mfma_f32_32x32x16_bf16 v[96:111], a[4:7], a[4:7], v[96:111]
    ds_read_b64_tr_b16 v[78:79], v11 offset:6656
    v_mfma_f32_16x16x32_bf16 v[84:87], v[80:83], a[4:7], v[84:87]
    s_barrier
    s_waitcnt lgkmcnt(5)
    v_mfma_f32_32x32x16_bf16 v[16:31], a[8:11], v[64:67], v[16:31]
    ds_read_b128 a[16:19], v6 offset:4096
    ds_read_b64_tr_b16 v[48:49], v10 offset:8192
    v_mfma_f32_32x32x16_bf16 v[32:47], a[8:11], v[68:71], v[32:47]
    ds_read_b64_tr_b16 v[50:51], v10 offset:8704
    ds_read_b64_tr_b16 v[52:53], v11 offset:8192
    v_mfma_f32_32x32x16_bf16 v[96:111], a[8:11], a[8:11], v[96:111]
    ds_read_b64_tr_b16 v[54:55], v11 offset:8704
    v_mfma_f32_16x16x32_bf16 v[84:87], v[80:83], a[8:11], v[84:87]
    s_waitcnt lgkmcnt(5)
    v_mfma_f32_32x32x16_bf16 v[16:31], a[12:15], v[72:75], v[16:31]
    ds_read_b128 a[20:23], v7 offset:4096
    ds_read_b64_tr_b16 v[56:57], v10 offset:10240
    v_mfma_f32_32x32x16_bf16 v[32:47], a[12:15], v[76:79], v[32:47]
    ds_read_b64_tr_b16 v[58:59], v10 offset:10752
    ds_read_b64_tr_b16 v[60:61], v11 offset:10240
    v_mfma_f32_32x32x16_bf16 v[96:111], a[12:15], a[12:15], v[96:111]
    ds_read_b64_tr_b16 v[62:63], v11 offset:10752
    v_mfma_f32_16x16x32_bf16 v[84:87], v[80:83], a[12:15], v[84:87]
    s_waitcnt lgkmcnt(5)
    v_mfma_f32_32x32x16_bf16 v[16:31], a[16:19], v[48:51], v[16:31]
    ds_read_b128 a[24:27], v8 offset:4096
    ds_read_b64_tr_b16 v[64:65], v10 offset:12288
    v_mfma_f32_32x32x16_bf16 v[32:47], a[16:19], v[52:55], v[32:47]
    ds_read_b64_tr_b16 v[66:67], v10 offset:12800
    ds_read_b64_tr_b16 v[68:69], v11 offset:12288
    v_mfma_f32_32x32x16_bf16 v[96:111], a[16:19], a[16:19], v[96:111]
    ds_read_b64_tr_b16 v[70:71], v11 offset:12800
    v_mfma_f32_16x16x32_bf16 v[84:87], v[80:83], a[16:19], v[84:87]
    s_waitcnt lgkmcnt(5)
    v_mfma_f32_32x32x16_bf16 v[16:31], a[20:23], v[56:59], v[16:31]
    ds_read_b128 a[28:31], v9 offset:4096
    ds_read_b64_tr_b16 v[72:73], v10 offset:14336
    v_mfma_f32_32x32x16_bf16 v[32:47], a[20:23], v[60:63], v[32:47]
    ds_read_b64_tr_b16 v[74:75], v10 offset:14848
    ds_read_b64_tr_b16 v[76:77], v11 offset:14336
    v_mfma_f32_32x32x16_bf16 v[96:111], a[20:23], a[20:23], v[96:111]
    ds_read_b64_tr_b16 v[78:79], v11 offset:14848
    v_mfma_f32_16x16x32_bf16 v[84:87], v[80:83], a[20:23], v[84:87]
    s_barrier
    s_waitcnt lgkmcnt(5)
    v_mfma_f32_32x32x16_bf16 v[16:31], a[24:27], v[64:67], v[16:31]
    ds_read_b128 a[32:35], v6 offset:8192
    ds_read_b64_tr_b16 v[48:49], v10 offset:16384
    v_mfma_f32_32x32x16_bf16 v[32:47], a[24:27], v[68:71], v[32:47]
    ds_read_b64_tr_b16 v[50:51], v10 offset:16896
    ds_read_b64_tr_b16 v[52:53], v11 offset:16384
    v_mfma_f32_32x32x16_bf16 v[96:111], a[24:27], a[24:27], v[96:111]
    ds_read_b64_tr_b16 v[54:55], v11 offset:16896
    v_mfma_f32_16x16x32_bf16 v[84:87], v[80:83], a[24:27], v[84:87]
    s_waitcnt lgkmcnt(5)
    v_mfma_f32_32x32x16_bf16 v[16:31], a[28:31], v[72:75], v[16:31]
    ds_read_b128 a[36:39], v7 offset:8192
    ds_read_b64_tr_b16 v[56:57], v10 offset:18432
    v_mfma_f32_32x32x16_bf16 v[32:47], a[28:31], v[76:79], v[32:47]
    ds_read_b64_tr_b16 v[58:59], v10 offset:18944
    ds_read_b64_tr_b16 v[60:61], v11 offset:18432
    v_mfma_f32_32x32x16_bf16 v[96:111], a[28:31], a[28:31], v[96:111]
    ds_read_b64_tr_b16 v[62:63], v11 offset:18944
    v_mfma_f32_16x16x32_bf16 v[84:87], v[80:83], a[28:31], v[84:87]
    s_waitcnt lgkmcnt(5)
    v_mfma_f32_32x32x16_bf16 v[16:31], a[32:35], v[48:51], v[16:31]
    ds_read_b128 a[40:43], v8 offset:8192
    ds_read_b64_tr_b16 v[64:65], v10 offset:20480
    v_mfma_f32_32x32x16_bf16 v[32:47], a[32:35], v[52:55], v[32:47]
    ds_read_b64_tr_b16 v[66:67], v10 offset:20992
    ds_read_b64_tr_b16 v[68:69], v11 offset:20480
    v_mfma_f32_32x32x16_bf16 v[96:111], a[32:35], a[32:35], v[96:111]
    ds_read_b64_tr_b16 v[70:71], v11 offset:20992
    v_mfma_f32_16x16x32_bf16 v[84:87], v[80:83], a[32:35], v[84:87]
    s_waitcnt lgkmcnt(5)
    v_mfma_f32_32x32x16_bf16 v[16:31], a[36:39], v[56:59], v[16:31]
    ds_read_b128 a[44:47], v9 offset:8192
    ds_read_b64_tr_b16 v[72:73], v10 offset:22528
    v_mfma_f32_32x32x16_bf16 v[32:47], a[36:39], v[60:63], v[32:47]
    ds_read_b64_tr_b16 v[74:75], v10 offset:23040
    ds_read_b64_tr_b16 v[76:77], v11 offset:22528
    v_mfma_f32_32x32x16_bf16 v[96:111], a[36:39], a[36:39], v[96:111]
    ds_read_b64_tr_b16 v[78:79], v11 offset:23040
    v_mfma_f32_16x16x32_bf16 v[84:87], v[80:83], a[36:39], v[84:87]
    s_barrier
    s_cmp_lg_u32 s83, 0
    s_cbranch_scc1 L_sequential_preLN__linear_attn_block__dense_activation_gelu__prompt_kernel_32
    s_cmp_eq_u32 s66, 3
    s_cbranch_scc1 L_sequential_preLN__linear_attn_block__dense_activation_gelu__prompt_kernel_33
    buffer_load_dword v127, v5, s[16:19], s82 offen
    s_branch L_sequential_preLN__linear_attn_block__dense_activation_gelu__prompt_kernel_32
L_sequential_preLN__linear_attn_block__dense_activation_gelu__prompt_kernel_33:
    buffer_load_dword v127, v5, s[20:23], s80 offen
L_sequential_preLN__linear_attn_block__dense_activation_gelu__prompt_kernel_32:
    s_waitcnt lgkmcnt(5)
    v_mfma_f32_32x32x16_bf16 v[16:31], a[40:43], v[64:67], v[16:31]
    ds_read_b128 a[48:51], v6 offset:12288
    ds_read_b64_tr_b16 v[48:49], v10 offset:24576
    v_mfma_f32_32x32x16_bf16 v[32:47], a[40:43], v[68:71], v[32:47]
    ds_read_b64_tr_b16 v[50:51], v10 offset:25088
    ds_read_b64_tr_b16 v[52:53], v11 offset:24576
    v_mfma_f32_32x32x16_bf16 v[96:111], a[40:43], a[40:43], v[96:111]
    ds_read_b64_tr_b16 v[54:55], v11 offset:25088
    v_mfma_f32_16x16x32_bf16 v[84:87], v[80:83], a[40:43], v[84:87]
    s_waitcnt lgkmcnt(5)
    v_mfma_f32_32x32x16_bf16 v[16:31], a[44:47], v[72:75], v[16:31]
    ds_read_b128 a[52:55], v7 offset:12288
    ds_read_b64_tr_b16 v[56:57], v10 offset:26624
    v_mfma_f32_32x32x16_bf16 v[32:47], a[44:47], v[76:79], v[32:47]
    ds_read_b64_tr_b16 v[58:59], v10 offset:27136
    ds_read_b64_tr_b16 v[60:61], v11 offset:26624
    v_mfma_f32_32x32x16_bf16 v[96:111], a[44:47], a[44:47], v[96:111]
    ds_read_b64_tr_b16 v[62:63], v11 offset:27136
    v_mfma_f32_16x16x32_bf16 v[84:87], v[80:83], a[44:47], v[84:87]
    s_waitcnt lgkmcnt(5)
    v_mfma_f32_32x32x16_bf16 v[16:31], a[48:51], v[48:51], v[16:31]
    ds_read_b128 a[56:59], v8 offset:12288
    ds_read_b64_tr_b16 v[64:65], v10 offset:28672
    v_mfma_f32_32x32x16_bf16 v[32:47], a[48:51], v[52:55], v[32:47]
    ds_read_b64_tr_b16 v[66:67], v10 offset:29184
    ds_read_b64_tr_b16 v[68:69], v11 offset:28672
    v_mfma_f32_32x32x16_bf16 v[96:111], a[48:51], a[48:51], v[96:111]
    ds_read_b64_tr_b16 v[70:71], v11 offset:29184
    v_mfma_f32_16x16x32_bf16 v[84:87], v[80:83], a[48:51], v[84:87]
    s_waitcnt lgkmcnt(5)
    v_mfma_f32_32x32x16_bf16 v[16:31], a[52:55], v[56:59], v[16:31]
    ds_read_b128 a[60:63], v9 offset:12288
    ds_read_b64_tr_b16 v[72:73], v10 offset:30720
    v_mfma_f32_32x32x16_bf16 v[32:47], a[52:55], v[60:63], v[32:47]
    ds_read_b64_tr_b16 v[74:75], v10 offset:31232
    ds_read_b64_tr_b16 v[76:77], v11 offset:30720
    v_mfma_f32_32x32x16_bf16 v[96:111], a[52:55], a[52:55], v[96:111]
    ds_read_b64_tr_b16 v[78:79], v11 offset:31232
    v_mfma_f32_16x16x32_bf16 v[84:87], v[80:83], a[52:55], v[84:87]
    s_barrier
    s_cmp_lg_u32 s83, 1
    s_cbranch_scc1 L_sequential_preLN__linear_attn_block__dense_activation_gelu__prompt_kernel_34
    s_cmp_eq_u32 s66, 3
    s_cbranch_scc1 L_sequential_preLN__linear_attn_block__dense_activation_gelu__prompt_kernel_35
    buffer_load_dword v127, v5, s[16:19], s82 offen
    s_branch L_sequential_preLN__linear_attn_block__dense_activation_gelu__prompt_kernel_34
L_sequential_preLN__linear_attn_block__dense_activation_gelu__prompt_kernel_35:
    buffer_load_dword v127, v5, s[20:23], s80 offen
L_sequential_preLN__linear_attn_block__dense_activation_gelu__prompt_kernel_34:
    s_waitcnt lgkmcnt(5)
    v_mfma_f32_32x32x16_bf16 v[16:31], a[56:59], v[64:67], v[16:31]
    ds_read_b128 a[64:67], v6 offset:16384
    ds_read_b64_tr_b16 v[48:49], v10 offset:32768
    v_mfma_f32_32x32x16_bf16 v[32:47], a[56:59], v[68:71], v[32:47]
    ds_read_b64_tr_b16 v[50:51], v10 offset:33280
    ds_read_b64_tr_b16 v[52:53], v11 offset:32768
    v_mfma_f32_32x32x16_bf16 v[96:111], a[56:59], a[56:59], v[96:111]
    ds_read_b64_tr_b16 v[54:55], v11 offset:33280
    v_mfma_f32_16x16x32_bf16 v[84:87], v[80:83], a[56:59], v[84:87]
    s_waitcnt lgkmcnt(5)
    v_mfma_f32_32x32x16_bf16 v[16:31], a[60:63], v[72:75], v[16:31]
    ds_read_b128 a[68:71], v7 offset:16384
    ds_read_b64_tr_b16 v[56:57], v10 offset:34816
    v_mfma_f32_32x32x16_bf16 v[32:47], a[60:63], v[76:79], v[32:47]
    ds_read_b64_tr_b16 v[58:59], v10 offset:35328
    ds_read_b64_tr_b16 v[60:61], v11 offset:34816
    v_mfma_f32_32x32x16_bf16 v[96:111], a[60:63], a[60:63], v[96:111]
    ds_read_b64_tr_b16 v[62:63], v11 offset:35328
    v_mfma_f32_16x16x32_bf16 v[84:87], v[80:83], a[60:63], v[84:87]
    s_waitcnt lgkmcnt(5)
    v_mfma_f32_32x32x16_bf16 v[16:31], a[64:67], v[48:51], v[16:31]
    ds_read_b128 a[72:75], v8 offset:16384
    ds_read_b64_tr_b16 v[64:65], v10 offset:36864
    v_mfma_f32_32x32x16_bf16 v[32:47], a[64:67], v[52:55], v[32:47]
    ds_read_b64_tr_b16 v[66:67], v10 offset:37376
    ds_read_b64_tr_b16 v[68:69], v11 offset:36864
    v_mfma_f32_32x32x16_bf16 v[96:111], a[64:67], a[64:67], v[96:111]
    ds_read_b64_tr_b16 v[70:71], v11 offset:37376
    v_mfma_f32_16x16x32_bf16 v[84:87], v[80:83], a[64:67], v[84:87]
    s_waitcnt lgkmcnt(5)
    v_mfma_f32_32x32x16_bf16 v[16:31], a[68:71], v[56:59], v[16:31]
    ds_read_b128 a[76:79], v9 offset:16384
    ds_read_b64_tr_b16 v[72:73], v10 offset:38912
    v_mfma_f32_32x32x16_bf16 v[32:47], a[68:71], v[60:63], v[32:47]
    ds_read_b64_tr_b16 v[74:75], v10 offset:39424
    ds_read_b64_tr_b16 v[76:77], v11 offset:38912
    v_mfma_f32_32x32x16_bf16 v[96:111], a[68:71], a[68:71], v[96:111]
    ds_read_b64_tr_b16 v[78:79], v11 offset:39424
    v_mfma_f32_16x16x32_bf16 v[84:87], v[80:83], a[68:71], v[84:87]
    s_waitcnt lgkmcnt(0)
    s_barrier
    s_cmp_lg_u32 s83, 0
    s_cbranch_scc1 L_sequential_preLN__linear_attn_block__dense_activation_gelu__prompt_kernel_36
    s_add_u32 s88, s82, 163840
    buffer_load_dword v127, v5, s[20:23], s88 offen
L_sequential_preLN__linear_attn_block__dense_activation_gelu__prompt_kernel_36:
    s_cmp_lg_u32 s83, 2
    s_cbranch_scc1 L_sequential_preLN__linear_attn_block__dense_activation_gelu__prompt_kernel_37
    s_cmp_eq_u32 s66, 3
    s_cbranch_scc1 L_sequential_preLN__linear_attn_block__dense_activation_gelu__prompt_kernel_38
    buffer_load_dword v127, v5, s[16:19], s82 offen
    s_branch L_sequential_preLN__linear_attn_block__dense_activation_gelu__prompt_kernel_37
L_sequential_preLN__linear_attn_block__dense_activation_gelu__prompt_kernel_38:
    buffer_load_dword v127, v5, s[20:23], s80 offen
L_sequential_preLN__linear_attn_block__dense_activation_gelu__prompt_kernel_37:
    v_mfma_f32_32x32x16_bf16 v[16:31], a[72:75], v[64:67], v[16:31]
    ds_read_b128 a[80:83], v6 offset:20480
    ds_read_b64_tr_b16 v[48:49], v10 offset:40960
    v_mfma_f32_32x32x16_bf16 v[32:47], a[72:75], v[68:71], v[32:47]
    ds_read_b64_tr_b16 v[50:51], v10 offset:41472
    ds_read_b64_tr_b16 v[52:53], v11 offset:40960
    v_mfma_f32_32x32x16_bf16 v[96:111], a[72:75], a[72:75], v[96:111]
    ds_read_b64_tr_b16 v[54:55], v11 offset:41472
    v_mfma_f32_16x16x32_bf16 v[84:87], v[80:83], a[72:75], v[84:87]
    v_mfma_f32_32x32x16_bf16 v[16:31], a[76:79], v[72:75], v[16:31]
    ds_read_b128 a[84:87], v7 offset:20480
    ds_read_b64_tr_b16 v[56:57], v10 offset:43008
    v_mfma_f32_32x32x16_bf16 v[32:47], a[76:79], v[76:79], v[32:47]
    ds_read_b64_tr_b16 v[58:59], v10 offset:43520
    ds_read_b64_tr_b16 v[60:61], v11 offset:43008
    v_mfma_f32_32x32x16_bf16 v[96:111], a[76:79], a[76:79], v[96:111]
    ds_read_b64_tr_b16 v[62:63], v11 offset:43520
    v_mfma_f32_16x16x32_bf16 v[84:87], v[80:83], a[76:79], v[84:87]
    s_waitcnt lgkmcnt(5)
    v_mfma_f32_32x32x16_bf16 v[16:31], a[80:83], v[48:51], v[16:31]
    ds_read_b128 a[88:91], v8 offset:20480
    ds_read_b64_tr_b16 v[64:65], v10 offset:45056
    v_mfma_f32_32x32x16_bf16 v[32:47], a[80:83], v[52:55], v[32:47]
    ds_read_b64_tr_b16 v[66:67], v10 offset:45568
    ds_read_b64_tr_b16 v[68:69], v11 offset:45056
    v_mfma_f32_32x32x16_bf16 v[96:111], a[80:83], a[80:83], v[96:111]
    ds_read_b64_tr_b16 v[70:71], v11 offset:45568
    v_mfma_f32_16x16x32_bf16 v[84:87], v[80:83], a[80:83], v[84:87]
    s_waitcnt lgkmcnt(5)
    v_mfma_f32_32x32x16_bf16 v[16:31], a[84:87], v[56:59], v[16:31]
    ds_read_b128 a[92:95], v9 offset:20480
    ds_read_b64_tr_b16 v[72:73], v10 offset:47104
    v_mfma_f32_32x32x16_bf16 v[32:47], a[84:87], v[60:63], v[32:47]
    ds_read_b64_tr_b16 v[74:75], v10 offset:47616
    ds_read_b64_tr_b16 v[76:77], v11 offset:47104
    v_mfma_f32_32x32x16_bf16 v[96:111], a[84:87], a[84:87], v[96:111]
    ds_read_b64_tr_b16 v[78:79], v11 offset:47616
    v_mfma_f32_16x16x32_bf16 v[84:87], v[80:83], a[84:87], v[84:87]
    s_barrier
    s_cmp_lg_u32 s83, 1
    s_cbranch_scc1 L_sequential_preLN__linear_attn_block__dense_activation_gelu__prompt_kernel_39
    s_add_u32 s88, s82, 163840
    buffer_load_dword v127, v5, s[20:23], s88 offen
L_sequential_preLN__linear_attn_block__dense_activation_gelu__prompt_kernel_39:
    s_cmp_lg_u32 s83, 2
    s_cbranch_scc1 L_sequential_preLN__linear_attn_block__dense_activation_gelu__prompt_kernel_40
    s_add_u32 s88, s82, 163840
    buffer_load_dword v127, v5, s[20:23], s88 offen
L_sequential_preLN__linear_attn_block__dense_activation_gelu__prompt_kernel_40:
    s_waitcnt lgkmcnt(5)
    v_mfma_f32_32x32x16_bf16 v[16:31], a[88:91], v[64:67], v[16:31]
    ds_read_b128 a[96:99], v6 offset:0
    ds_read_b64_tr_b16 v[48:49], v10 offset:49152
    v_mfma_f32_32x32x16_bf16 v[32:47], a[88:91], v[68:71], v[32:47]
    ds_read_b64_tr_b16 v[50:51], v10 offset:49664
    ds_read_b64_tr_b16 v[52:53], v11 offset:49152
    v_mfma_f32_32x32x16_bf16 v[96:111], a[88:91], a[88:91], v[96:111]
    ds_read_b64_tr_b16 v[54:55], v11 offset:49664
    v_mfma_f32_16x16x32_bf16 v[84:87], v[80:83], a[88:91], v[84:87]
    s_waitcnt lgkmcnt(5)
    v_mfma_f32_32x32x16_bf16 v[16:31], a[92:95], v[72:75], v[16:31]
    ds_read_b128 a[100:103], v7 offset:0
    ds_read_b64_tr_b16 v[56:57], v10 offset:51200
    v_mfma_f32_32x32x16_bf16 v[32:47], a[92:95], v[76:79], v[32:47]
    ds_read_b64_tr_b16 v[58:59], v10 offset:51712
    ds_read_b64_tr_b16 v[60:61], v11 offset:51200
    v_mfma_f32_32x32x16_bf16 v[96:111], a[92:95], a[92:95], v[96:111]
    ds_read_b64_tr_b16 v[62:63], v11 offset:51712
    v_mfma_f32_16x16x32_bf16 v[84:87], v[80:83], a[92:95], v[84:87]
    s_waitcnt lgkmcnt(5)
    v_mfma_f32_32x32x16_bf16 v[16:31], a[96:99], v[48:51], v[16:31]
    ds_read_b128 a[104:107], v8 offset:0
    ds_read_b64_tr_b16 v[64:65], v10 offset:53248
    v_mfma_f32_32x32x16_bf16 v[32:47], a[96:99], v[52:55], v[32:47]
    ds_read_b64_tr_b16 v[66:67], v10 offset:53760
    ds_read_b64_tr_b16 v[68:69], v11 offset:53248
    v_mfma_f32_32x32x16_bf16 v[96:111], a[96:99], a[96:99], v[96:111]
    ds_read_b64_tr_b16 v[70:71], v11 offset:53760
    v_mfma_f32_16x16x32_bf16 v[84:87], v[80:83], a[96:99], v[84:87]
    s_waitcnt lgkmcnt(5)
    v_mfma_f32_32x32x16_bf16 v[16:31], a[100:103], v[56:59], v[16:31]
    ds_read_b128 a[108:111], v9 offset:0
    ds_read_b64_tr_b16 v[72:73], v10 offset:55296
    v_mfma_f32_32x32x16_bf16 v[32:47], a[100:103], v[60:63], v[32:47]
    ds_read_b64_tr_b16 v[74:75], v10 offset:55808
    ds_read_b64_tr_b16 v[76:77], v11 offset:55296
    v_mfma_f32_32x32x16_bf16 v[96:111], a[100:103], a[100:103], v[96:111]
    ds_read_b64_tr_b16 v[78:79], v11 offset:55808
    v_mfma_f32_16x16x32_bf16 v[84:87], v[80:83], a[100:103], v[84:87]
    s_waitcnt lgkmcnt(5)
    v_mfma_f32_32x32x16_bf16 v[16:31], a[104:107], v[64:67], v[16:31]
    v_mfma_f32_32x32x16_bf16 v[32:47], a[104:107], v[68:71], v[32:47]
    v_mfma_f32_32x32x16_bf16 v[96:111], a[104:107], a[104:107], v[96:111]
    v_mfma_f32_16x16x32_bf16 v[84:87], v[80:83], a[104:107], v[84:87]
    s_waitcnt lgkmcnt(0)
    v_mfma_f32_32x32x16_bf16 v[16:31], a[108:111], v[72:75], v[16:31]
    v_mfma_f32_32x32x16_bf16 v[32:47], a[108:111], v[76:79], v[32:47]
    v_mfma_f32_32x32x16_bf16 v[96:111], a[108:111], a[108:111], v[96:111]
    v_mfma_f32_16x16x32_bf16 v[84:87], v[80:83], a[108:111], v[84:87]
    v_bfe_u32 v112, v1, 3, 2
    v_and_b32 v113, 3, v1
    v_lshl_add_u32 v112, v112, 2, v113
    v_bfe_u32 v113, v1, 2, 1
    v_lshrrev_b32 v114, 5, v1
    v_xor_b32 v113, v113, v114
    v_lshl_add_u32 v112, v113, 4, v112
    v_mov_b32 v15, 0
    s_lshl_b32 s88, s66, 8
    s_add_u32 s88, s88, 155648
    v_lshlrev_b32 v114, 4, v114
    v_add_u32 v114, s88, v114
    v_lshlrev_b32 v13, 2, v1
    v_add_u32 v13, s88, v13
    v_cmp_eq_u32 s[92:93], 0, v112
    v_cmp_eq_u32 s[94:95], 1, v112
    s_nop 0
    v_cndmask_b32 v15, v15, v96, s[92:93]
    v_cmp_eq_u32 s[92:93], 2, v112
    v_cndmask_b32 v15, v15, v97, s[94:95]
    v_cmp_eq_u32 s[94:95], 3, v112
    v_cndmask_b32 v15, v15, v98, s[92:93]
    v_cmp_eq_u32 s[92:93], 4, v112
    v_cndmask_b32 v15, v15, v99, s[94:95]
    v_cmp_eq_u32 s[94:95], 5, v112
    v_cndmask_b32 v15, v15, v100, s[92:93]
    v_cmp_eq_u32 s[92:93], 6, v112
    v_cndmask_b32 v15, v15, v101, s[94:95]
    v_cmp_eq_u32 s[94:95], 7, v112
    v_cndmask_b32 v15, v15, v102, s[92:93]
    v_cmp_eq_u32 s[92:93], 8, v112
    v_cndmask_b32 v15, v15, v103, s[94:95]
    v_cmp_eq_u32 s[94:95], 9, v112
    v_cndmask_b32 v15, v15, v104, s[92:93]
    v_cmp_eq_u32 s[92:93], 10, v112
    v_cndmask_b32 v15, v15, v105, s[94:95]
    v_cmp_eq_u32 s[94:95], 11, v112
    v_cndmask_b32 v15, v15, v106, s[92:93]
    v_cmp_eq_u32 s[92:93], 12, v112
    v_cndmask_b32 v15, v15, v107, s[94:95]
    v_cmp_eq_u32 s[94:95], 13, v112
    v_cndmask_b32 v15, v15, v108, s[92:93]
    v_cmp_eq_u32 s[92:93], 14, v112
    v_cndmask_b32 v15, v15, v109, s[94:95]
    v_cmp_eq_u32 s[94:95], 15, v112
    v_cndmask_b32 v15, v15, v110, s[92:93]
    s_nop 0
    v_cndmask_b32 v15, v15, v111, s[94:95]
    v_bfe_u32 v112, v1, 4, 1
    v_cmp_eq_u32 vcc, 1, v112
    v_mov_b32 v113, v15
    s_nop 0
    v_cndmask_b32 v14, v84, v85, vcc
    v_permlane32_swap_b32 v15, v113
    v_add_f32 v15, v15, v113
    v_mul_f32 v14, 0x3b124925, v14
    v_mul_f32 v15, 0x3b124925, v15
    v_fma_f32 v15, -v14, v14, v15
    v_max_f32 v15, 0, v15
    v_add_f32 v15, 0x3727c5ac, v15
    v_rsq_f32 v15, v15
    v_cmp_gt_u32 vcc, 32, v1
    v_mul_f32 v14, v14, v15
    s_nop 0
    v_cndmask_b32 v112, v14, v15, vcc
    ds_write_b32 v13, v112
    v_and_b32 v112, 31, v1
    v_lshlrev_b32 v113, 2, v112
    v_add_u32 v113, 156672, v113
    s_mov_b32 s96, 0x358637bd
    s_mov_b32 s97, 0x3fb8aa3b
    v_mov_b32 v117, 0xb5c1a2a0
    v_mov_b32 v118, s96
    v_cmp_eq_u32 vcc, 28, v112
    v_cmp_gt_u32 s[92:93], 28, v112
    v_mov_b32 v119, 0x3f803f80
    s_waitcnt lgkmcnt(0)
    s_barrier
    ds_read_b32 v64, v113 offset:0
    ds_read_b32 v68, v113 offset:128
    ds_read_b32 v65, v113 offset:256
    ds_read_b32 v69, v113 offset:384
    ds_read_b32 v66, v113 offset:512
    ds_read_b32 v70, v113 offset:640
    ds_read_b32 v67, v113 offset:768
    ds_read_b32 v71, v113 offset:896
    ds_read_b128 v[80:83], v114 offset:0
    ds_read_b128 v[96:99], v114 offset:128
    ds_read_b128 v[84:87], v114 offset:32
    ds_read_b128 v[100:103], v114 offset:160
    ds_read_b128 v[88:91], v114 offset:64
    ds_read_b128 v[104:107], v114 offset:192
    ds_read_b128 v[92:95], v114 offset:96
    ds_read_b128 v[108:111], v114 offset:224
    v_bfe_u32 v112, v1, 4, 1
    v_lshlrev_b32 v112, 11, v112
    v_lshrrev_b32 v120, 5, v1
    v_lshl_add_u32 v112, v120, 10, v112
    v_and_b32 v120, 15, v1
    v_lshl_add_u32 v112, v120, 4, v112
    s_lshr_b32 s88, s66, 1
    s_mul_i32 s88, s88, 24576
    s_and_b32 s89, s66, 1
    s_mul_i32 s89, s89, 20480
    s_add_u32 s88, s88, s89
    s_add_u32 s88, s88, 106496
    v_add_u32 v112, s88, v112
    s_waitcnt lgkmcnt(8)
    v_add_f32 v115, v64, v65
    v_add_f32 v116, v68, v69
    v_add_f32 v66, v66, v67
    v_add_f32 v70, v70, v71
    v_add_f32 v115, v115, v66
    v_add_f32 v116, v116, v70
    s_waitcnt lgkmcnt(6)
    v_fma_f32 v64, -v96, v115, v118
    v_mul_f32 v72, v96, v116
    v_fma_f32 v65, -v97, v115, v118
    v_mul_f32 v73, v97, v116
    v_fma_f32 v66, -v98, v115, v118
    v_mul_f32 v74, v98, v116
    v_fma_f32 v67, -v99, v115, v118
    v_mul_f32 v75, v99, v116
    v_fma_f32 v16, v16, v80, v64
    v_fma_f32 v17, v17, v81, v65
    v_fma_f32 v18, v18, v82, v66
    v_fma_f32 v19, v19, v83, v67
    v_fma_f32 v68, v16, s97, v117
    v_fma_f32 v69, v17, s97, v117
    v_fma_f32 v70, v18, s97, v117
    v_fma_f32 v71, v19, s97, v117
    v_min_f32 v68, 0, v68
    v_min_f32 v69, 0, v69
    v_min_f32 v70, 0, v70
    v_min_f32 v71, 0, v71
    v_exp_f32 v68, v68
    v_exp_f32 v69, v69
    v_exp_f32 v70, v70
    v_exp_f32 v71, v71
    v_max_f32 v16, s96, v16
    v_max_f32 v17, s96, v17
    v_max_f32 v18, s96, v18
    v_max_f32 v19, s96, v19
    v_add_f32 v16, v16, v68
    v_add_f32 v17, v17, v69
    v_add_f32 v18, v18, v70
    v_add_f32 v19, v19, v71
    v_fma_f32 v32, v32, v80, -v72
    v_fma_f32 v33, v33, v81, -v73
    v_fma_f32 v34, v34, v82, -v74
    v_fma_f32 v35, v35, v83, -v75
    v_cvt_pk_bf16_f32 v48, v16, v17
    v_cvt_pk_bf16_f32 v56, v32, v33
    v_cndmask_b32 v56, v56, v119, vcc
    v_cndmask_b32 v48, 0, v48, s[92:93]
    v_cvt_pk_bf16_f32 v49, v18, v19
    v_cvt_pk_bf16_f32 v57, v34, v35
    v_cndmask_b32 v57, v57, v119, vcc
    v_cndmask_b32 v49, 0, v49, s[92:93]
    s_waitcnt lgkmcnt(4)
    v_fma_f32 v64, -v100, v115, v118
    v_mul_f32 v72, v100, v116
    v_fma_f32 v65, -v101, v115, v118
    v_mul_f32 v73, v101, v116
    v_fma_f32 v66, -v102, v115, v118
    v_mul_f32 v74, v102, v116
    v_fma_f32 v67, -v103, v115, v118
    v_mul_f32 v75, v103, v116
    v_fma_f32 v20, v20, v84, v64
    v_fma_f32 v21, v21, v85, v65
    v_fma_f32 v22, v22, v86, v66
    v_fma_f32 v23, v23, v87, v67
    v_fma_f32 v68, v20, s97, v117
    v_fma_f32 v69, v21, s97, v117
    v_fma_f32 v70, v22, s97, v117
    v_fma_f32 v71, v23, s97, v117
    v_min_f32 v68, 0, v68
    v_min_f32 v69, 0, v69
    v_min_f32 v70, 0, v70
    v_min_f32 v71, 0, v71
    v_exp_f32 v68, v68
    v_exp_f32 v69, v69
    v_exp_f32 v70, v70
    v_exp_f32 v71, v71
    v_max_f32 v20, s96, v20
    v_max_f32 v21, s96, v21
    v_max_f32 v22, s96, v22
    v_max_f32 v23, s96, v23
    v_add_f32 v20, v20, v68
    v_add_f32 v21, v21, v69
    v_add_f32 v22, v22, v70
    v_add_f32 v23, v23, v71
    v_fma_f32 v36, v36, v84, -v72
    v_fma_f32 v37, v37, v85, -v73
    v_fma_f32 v38, v38, v86, -v74
    v_fma_f32 v39, v39, v87, -v75
    v_cvt_pk_bf16_f32 v50, v20, v21
    v_cvt_pk_bf16_f32 v58, v36, v37
    v_cndmask_b32 v58, v58, v119, vcc
    v_cndmask_b32 v50, 0, v50, s[92:93]
    v_cvt_pk_bf16_f32 v51, v22, v23
    v_cvt_pk_bf16_f32 v59, v38, v39
    v_cndmask_b32 v59, v59, v119, vcc
    v_cndmask_b32 v51, 0, v51, s[92:93]
    s_nop 1
    v_mfma_f32_32x32x16_bf16 a[112:127], v[48:51], v[56:59], 0
    s_waitcnt lgkmcnt(2)
    v_fma_f32 v64, -v104, v115, v118
    v_mul_f32 v72, v104, v116
    v_fma_f32 v65, -v105, v115, v118
    v_mul_f32 v73, v105, v116
    v_fma_f32 v66, -v106, v115, v118
    v_mul_f32 v74, v106, v116
    v_fma_f32 v67, -v107, v115, v118
    v_mul_f32 v75, v107, v116
    v_fma_f32 v24, v24, v88, v64
    v_fma_f32 v25, v25, v89, v65
    v_fma_f32 v26, v26, v90, v66
    v_fma_f32 v27, v27, v91, v67
    v_fma_f32 v68, v24, s97, v117
    v_fma_f32 v69, v25, s97, v117
    v_fma_f32 v70, v26, s97, v117
    v_fma_f32 v71, v27, s97, v117
    v_min_f32 v68, 0, v68
    v_min_f32 v69, 0, v69
    v_min_f32 v70, 0, v70
    v_min_f32 v71, 0, v71
    v_exp_f32 v68, v68
    v_exp_f32 v69, v69
    v_exp_f32 v70, v70
    v_exp_f32 v71, v71
    v_max_f32 v24, s96, v24
    v_max_f32 v25, s96, v25
    v_max_f32 v26, s96, v26
    v_max_f32 v27, s96, v27
    v_add_f32 v24, v24, v68
    v_add_f32 v25, v25, v69
    v_add_f32 v26, v26, v70
    v_add_f32 v27, v27, v71
    v_fma_f32 v40, v40, v88, -v72
    v_fma_f32 v41, v41, v89, -v73
    v_fma_f32 v42, v42, v90, -v74
    v_fma_f32 v43, v43, v91, -v75
    v_cvt_pk_bf16_f32 v52, v24, v25
    v_cvt_pk_bf16_f32 v60, v40, v41
    v_cndmask_b32 v60, v60, v119, vcc
    v_cndmask_b32 v52, 0, v52, s[92:93]
    v_cvt_pk_bf16_f32 v53, v26, v27
    v_cvt_pk_bf16_f32 v61, v42, v43
    v_cndmask_b32 v61, v61, v119, vcc
    v_cndmask_b32 v53, 0, v53, s[92:93]
    s_waitcnt lgkmcnt(0)
    v_fma_f32 v64, -v108, v115, v118
    v_mul_f32 v72, v108, v116
    v_fma_f32 v65, -v109, v115, v118
    v_mul_f32 v73, v109, v116
    v_fma_f32 v66, -v110, v115, v118
    v_mul_f32 v74, v110, v116
    v_fma_f32 v67, -v111, v115, v118
    v_mul_f32 v75, v111, v116
    v_fma_f32 v28, v28, v92, v64
    v_fma_f32 v29, v29, v93, v65
    v_fma_f32 v30, v30, v94, v66
    v_fma_f32 v31, v31, v95, v67
    v_fma_f32 v68, v28, s97, v117
    v_fma_f32 v69, v29, s97, v117
    v_fma_f32 v70, v30, s97, v117
    v_fma_f32 v71, v31, s97, v117
    v_min_f32 v68, 0, v68
    v_min_f32 v69, 0, v69
    v_min_f32 v70, 0, v70
    v_min_f32 v71, 0, v71
    v_exp_f32 v68, v68
    v_exp_f32 v69, v69
    v_exp_f32 v70, v70
    v_exp_f32 v71, v71
    v_max_f32 v28, s96, v28
    v_max_f32 v29, s96, v29
    v_max_f32 v30, s96, v30
    v_max_f32 v31, s96, v31
    v_add_f32 v28, v28, v68
    v_add_f32 v29, v29, v69
    v_add_f32 v30, v30, v70
    v_add_f32 v31, v31, v71
    v_fma_f32 v44, v44, v92, -v72
    v_fma_f32 v45, v45, v93, -v73
    v_fma_f32 v46, v46, v94, -v74
    v_fma_f32 v47, v47, v95, -v75
    v_cvt_pk_bf16_f32 v54, v28, v29
    v_cvt_pk_bf16_f32 v62, v44, v45
    v_cndmask_b32 v62, v62, v119, vcc
    v_cndmask_b32 v54, 0, v54, s[92:93]
    v_cvt_pk_bf16_f32 v55, v30, v31
    v_cvt_pk_bf16_f32 v63, v46, v47
    v_cndmask_b32 v63, v63, v119, vcc
    v_cndmask_b32 v55, 0, v55, s[92:93]
    s_nop 1
    v_mfma_f32_32x32x16_bf16 a[112:127], v[52:55], v[60:63], a[112:127]
    s_nop 11
    ds_write_b128 v112, a[112:115] offset:0
    ds_write_b128 v112, a[116:119] offset:256
    ds_write_b128 v112, a[120:123] offset:512
    ds_write_b128 v112, a[124:127] offset:768
    s_waitcnt lgkmcnt(0)
    v_mov_b32 v113, 163768
    v_mov_b32 v114, 1
    s_mov_b64 exec, 1
    ds_add_u32 v113, v114
    s_mov_b64 exec, -1
    v_mov_b32 v113, 163772
    s_mov_b32 s99, 0
    s_branch L_sequential_preLN__linear_attn_block__dense_activation_gelu__prompt_kernel_41_f
L_sequential_preLN__linear_attn_block__dense_activation_gelu__prompt_kernel_41:
    s_sleep 1
L_sequential_preLN__linear_attn_block__dense_activation_gelu__prompt_kernel_41_f:
    ds_read_b32 v114, v113
    s_add_u32 s99, s99, 1
    s_waitcnt lgkmcnt(0)
    v_readfirstlane_b32 s98, v114
    s_cmp_gt_u32 s99, 800000
    s_cbranch_scc1 L_sequential_preLN__linear_attn_block__dense_activation_gelu__prompt_kernel_41_x
    s_cmp_lt_u32 s98, 4
    s_cbranch_scc1 L_sequential_preLN__linear_attn_block__dense_activation_gelu__prompt_kernel_41
L_sequential_preLN__linear_attn_block__dense_activation_gelu__prompt_kernel_41_x:
    v_mov_b32 v120, v119
    v_mov_b32 v121, v119
    v_mov_b32 v122, v119
    v_mov_b32 v123, v119
    ds_read_b64_tr_b16 v[48:49], v12 offset:0
    ds_read_b64_tr_b16 v[50:51], v12 offset:256
    ds_read_b64_tr_b16 v[52:53], v12 offset:1024
    ds_read_b64_tr_b16 v[54:55], v12 offset:1280
    ds_read_b64_tr_b16 v[56:57], v12 offset:2048
    ds_read_b64_tr_b16 v[58:59], v12 offset:2304
    s_lshl_b32 s88, s75, 3
    s_lshl_b32 s89, s66, 1
    s_add_u32 s88, s88, s89
    s_lshl_b32 s88, s88, 4
    s_add_u32 s88, s88, s74
    s_lshl_b32 s88, s88, 10
    s_add_u32 s91, s88, 1048576
    v_bfe_u32 v112, v1, 4, 1
    v_lshlrev_b32 v112, 14, v112
    v_lshrrev_b32 v113, 5, v1
    v_lshl_add_u32 v112, v113, 8, v112
    v_and_b32 v113, 15, v1
    v_lshl_add_u32 v112, v113, 4, v112
    ds_read_b64_tr_b16 v[60:61], v12 offset:3072
    ds_read_b64_tr_b16 v[62:63], v12 offset:3328
    s_waitcnt lgkmcnt(6)
    v_mfma_f32_32x32x16_bf16 v[80:95], v[48:51], a[0:3], 0
    ds_read_b64_tr_b16 v[64:65], v12 offset:4096
    ds_read_b64_tr_b16 v[66:67], v12 offset:4352
    s_waitcnt lgkmcnt(6)
    v_mfma_f32_32x32x16_bf16 v[80:95], v[52:55], a[4:7], v[80:95]
    ds_read_b64_tr_b16 v[68:69], v12 offset:5120
    ds_read_b64_tr_b16 v[70:71], v12 offset:5376
    s_waitcnt lgkmcnt(6)
    v_mfma_f32_32x32x16_bf16 v[80:95], v[56:59], a[8:11], v[80:95]
    ds_read_b64_tr_b16 v[72:73], v12 offset:6144
    ds_read_b64_tr_b16 v[74:75], v12 offset:6400
    s_waitcnt lgkmcnt(6)
    v_mfma_f32_32x32x16_bf16 v[80:95], v[60:63], a[12:15], v[80:95]
    ds_read_b64_tr_b16 v[76:77], v12 offset:7168
    ds_read_b64_tr_b16 v[78:79], v12 offset:7424
    s_waitcnt lgkmcnt(6)
    v_mfma_f32_32x32x16_bf16 v[80:95], v[64:67], a[16:19], v[80:95]
    ds_read_b64_tr_b16 v[48:49], v12 offset:8192
    ds_read_b64_tr_b16 v[50:51], v12 offset:8448
    s_waitcnt lgkmcnt(6)
    v_mfma_f32_32x32x16_bf16 v[80:95], v[68:71], a[20:23], v[80:95]
    ds_read_b64_tr_b16 v[52:53], v12 offset:9216
    ds_read_b64_tr_b16 v[54:55], v12 offset:9472
    s_waitcnt lgkmcnt(6)
    v_mfma_f32_32x32x16_bf16 v[80:95], v[72:75], a[24:27], v[80:95]
    ds_read_b64_tr_b16 v[56:57], v12 offset:10240
    ds_read_b64_tr_b16 v[58:59], v12 offset:10496
    s_waitcnt lgkmcnt(6)
    v_mfma_f32_32x32x16_bf16 v[80:95], v[76:79], a[28:31], v[80:95]
    ds_read_b64_tr_b16 v[60:61], v12 offset:11264
    ds_read_b64_tr_b16 v[62:63], v12 offset:11520
    s_waitcnt lgkmcnt(6)
    v_mfma_f32_32x32x16_bf16 v[80:95], v[48:51], a[32:35], v[80:95]
    ds_read_b64_tr_b16 v[64:65], v12 offset:12288
    ds_read_b64_tr_b16 v[66:67], v12 offset:12544
    s_waitcnt lgkmcnt(6)
    v_mfma_f32_32x32x16_bf16 v[80:95], v[52:55], a[36:39], v[80:95]
    ds_read_b64_tr_b16 v[68:69], v12 offset:13312
    ds_read_b64_tr_b16 v[70:71], v12 offset:13568
    s_waitcnt lgkmcnt(6)
    v_mfma_f32_32x32x16_bf16 v[80:95], v[56:59], a[40:43], v[80:95]
    ds_read_b64_tr_b16 v[72:73], v12 offset:24576
    ds_read_b64_tr_b16 v[74:75], v12 offset:24832
    s_waitcnt lgkmcnt(6)
    v_mfma_f32_32x32x16_bf16 v[80:95], v[60:63], a[44:47], v[80:95]
    ds_read_b64_tr_b16 v[76:77], v12 offset:25600
    ds_read_b64_tr_b16 v[78:79], v12 offset:25856
    s_waitcnt lgkmcnt(6)
    v_mfma_f32_32x32x16_bf16 v[80:95], v[64:67], a[48:51], v[80:95]
    ds_read_b64_tr_b16 v[48:49], v12 offset:26624
    ds_read_b64_tr_b16 v[50:51], v12 offset:26880
    s_waitcnt lgkmcnt(6)
    v_mfma_f32_32x32x16_bf16 v[80:95], v[68:71], a[52:55], v[80:95]
    ds_read_b64_tr_b16 v[52:53], v12 offset:27648
    ds_read_b64_tr_b16 v[54:55], v12 offset:27904
    s_waitcnt lgkmcnt(6)
    v_mfma_f32_32x32x16_bf16 v[80:95], v[72:75], a[56:59], v[80:95]
    ds_read_b64_tr_b16 v[56:57], v12 offset:28672
    ds_read_b64_tr_b16 v[58:59], v12 offset:28928
    s_waitcnt lgkmcnt(6)
    v_mfma_f32_32x32x16_bf16 v[80:95], v[76:79], a[60:63], v[80:95]
    ds_read_b64_tr_b16 v[60:61], v12 offset:29696
    ds_read_b64_tr_b16 v[62:63], v12 offset:29952
    s_waitcnt lgkmcnt(6)
    v_mfma_f32_32x32x16_bf16 v[80:95], v[48:51], a[64:67], v[80:95]
    ds_read_b64_tr_b16 v[64:65], v12 offset:30720
    ds_read_b64_tr_b16 v[66:67], v12 offset:30976
    s_waitcnt lgkmcnt(6)
    v_mfma_f32_32x32x16_bf16 v[80:95], v[52:55], a[68:71], v[80:95]
    ds_read_b64_tr_b16 v[68:69], v12 offset:31744
    ds_read_b64_tr_b16 v[70:71], v12 offset:32000
    s_waitcnt lgkmcnt(6)
    v_mfma_f32_32x32x16_bf16 v[80:95], v[56:59], a[72:75], v[80:95]
    ds_read_b64_tr_b16 v[72:73], v12 offset:32768
    ds_read_b64_tr_b16 v[74:75], v12 offset:33024
    s_waitcnt lgkmcnt(6)
    v_mfma_f32_32x32x16_bf16 v[80:95], v[60:63], a[76:79], v[80:95]
    ds_read_b64_tr_b16 v[76:77], v12 offset:33792
    ds_read_b64_tr_b16 v[78:79], v12 offset:34048
    s_waitcnt lgkmcnt(6)
    v_mfma_f32_32x32x16_bf16 v[80:95], v[64:67], a[80:83], v[80:95]
    ds_read_b64_tr_b16 v[48:49], v12 offset:34816
    ds_read_b64_tr_b16 v[50:51], v12 offset:35072
    s_waitcnt lgkmcnt(6)
    v_mfma_f32_32x32x16_bf16 v[80:95], v[68:71], a[84:87], v[80:95]
    ds_read_b64_tr_b16 v[52:53], v12 offset:35840
    ds_read_b64_tr_b16 v[54:55], v12 offset:36096
    s_waitcnt lgkmcnt(6)
    v_mfma_f32_32x32x16_bf16 v[80:95], v[72:75], a[88:91], v[80:95]
    ds_read_b64_tr_b16 v[56:57], v12 offset:36864
    ds_read_b64_tr_b16 v[58:59], v12 offset:37120
    s_waitcnt lgkmcnt(6)
    v_mfma_f32_32x32x16_bf16 v[80:95], v[76:79], a[92:95], v[80:95]
    ds_read_b64_tr_b16 v[60:61], v12 offset:37888
    ds_read_b64_tr_b16 v[62:63], v12 offset:38144
    s_waitcnt lgkmcnt(6)
    v_mfma_f32_32x32x16_bf16 v[80:95], v[48:51], a[96:99], v[80:95]
    s_waitcnt lgkmcnt(4)
    v_mfma_f32_32x32x16_bf16 v[80:95], v[52:55], a[100:103], v[80:95]
    s_waitcnt lgkmcnt(2)
    v_mfma_f32_32x32x16_bf16 v[80:95], v[56:59], a[104:107], v[80:95]
    s_waitcnt lgkmcnt(0)
    v_mfma_f32_32x32x16_bf16 v[80:95], v[60:63], a[108:111], v[80:95]
    v_mov_b32 v113, 163776
    s_mov_b32 s99, 0
    s_branch L_sequential_preLN__linear_attn_block__dense_activation_gelu__prompt_kernel_42_f
L_sequential_preLN__linear_attn_block__dense_activation_gelu__prompt_kernel_42:
    s_sleep 1
L_sequential_preLN__linear_attn_block__dense_activation_gelu__prompt_kernel_42_f:
    ds_read_b32 v114, v113
    s_add_u32 s99, s99, 1
    s_waitcnt lgkmcnt(0)
    v_readfirstlane_b32 s98, v114
    s_cmp_gt_u32 s99, 800000
    s_cbranch_scc1 L_sequential_preLN__linear_attn_block__dense_activation_gelu__prompt_kernel_42_x
    s_cmp_lt_u32 s98, 2
    s_cbranch_scc1 L_sequential_preLN__linear_attn_block__dense_activation_gelu__prompt_kernel_42
L_sequential_preLN__linear_attn_block__dense_activation_gelu__prompt_kernel_42_x:
    v_lshrrev_b32 v113, 5, v1
    v_lshlrev_b32 v113, 4, v113
    v_add_u32 v113, 157696, v113
    ds_read_b128 v[16:19], v113 offset:0
    ds_read_b128 v[32:35], v113 offset:128
    ds_read_b128 v[20:23], v113 offset:32
    ds_read_b128 v[36:39], v113 offset:160
    ds_read_b128 v[24:27], v113 offset:64
    ds_read_b128 v[40:43], v113 offset:192
    ds_read_b128 v[28:31], v113 offset:96
    ds_read_b128 v[44:47], v113 offset:224
    v_cmp_gt_u32 vcc, 32, v1
    s_waitcnt lgkmcnt(6)
    v_add_f32 v16, v16, v32
    v_add_f32 v17, v17, v33
    v_add_f32 v18, v18, v34
    v_add_f32 v19, v19, v35
    v_fma_f32 v64, -v14, v16, v118
    v_fma_f32 v65, -v14, v17, v118
    v_fma_f32 v66, -v14, v18, v118
    v_fma_f32 v67, -v14, v19, v118
    v_fma_f32 v80, v80, v15, v64
    v_fma_f32 v81, v81, v15, v65
    v_fma_f32 v82, v82, v15, v66
    v_fma_f32 v83, v83, v15, v67
    v_fma_f32 v68, v80, s97, v117
    v_fma_f32 v69, v81, s97, v117
    v_fma_f32 v70, v82, s97, v117
    v_fma_f32 v71, v83, s97, v117
    v_min_f32 v68, 0, v68
    v_min_f32 v69, 0, v69
    v_min_f32 v70, 0, v70
    v_min_f32 v71, 0, v71
    v_exp_f32 v68, v68
    v_exp_f32 v69, v69
    v_exp_f32 v70, v70
    v_exp_f32 v71, v71
    v_max_f32 v80, s96, v80
    v_max_f32 v81, s96, v81
    v_max_f32 v82, s96, v82
    v_max_f32 v83, s96, v83
    v_add_f32 v80, v80, v68
    v_add_f32 v81, v81, v69
    v_add_f32 v82, v82, v70
    v_add_f32 v83, v83, v71
    v_cvt_pk_bf16_f32 v48, v80, v81
    v_cvt_pk_bf16_f32 v49, v82, v83
    s_waitcnt lgkmcnt(4)
    v_add_f32 v20, v20, v36
    v_add_f32 v21, v21, v37
    v_add_f32 v22, v22, v38
    v_add_f32 v23, v23, v39
    v_fma_f32 v64, -v14, v20, v118
    v_fma_f32 v65, -v14, v21, v118
    v_fma_f32 v66, -v14, v22, v118
    v_fma_f32 v67, -v14, v23, v118
    v_fma_f32 v84, v84, v15, v64
    v_fma_f32 v85, v85, v15, v65
    v_fma_f32 v86, v86, v15, v66
    v_fma_f32 v87, v87, v15, v67
    v_fma_f32 v68, v84, s97, v117
    v_fma_f32 v69, v85, s97, v117
    v_fma_f32 v70, v86, s97, v117
    v_fma_f32 v71, v87, s97, v117
    v_min_f32 v68, 0, v68
    v_min_f32 v69, 0, v69
    v_min_f32 v70, 0, v70
    v_min_f32 v71, 0, v71
    v_exp_f32 v68, v68
    v_exp_f32 v69, v69
    v_exp_f32 v70, v70
    v_exp_f32 v71, v71
    v_max_f32 v84, s96, v84
    v_max_f32 v85, s96, v85
    v_max_f32 v86, s96, v86
    v_max_f32 v87, s96, v87
    v_add_f32 v84, v84, v68
    v_add_f32 v85, v85, v69
    v_add_f32 v86, v86, v70
    v_add_f32 v87, v87, v71
    v_cvt_pk_bf16_f32 v50, v84, v85
    v_cvt_pk_bf16_f32 v51, v86, v87
    buffer_store_dwordx4 v[48:51], v112, s[44:47], s91 offen  sc1
    s_waitcnt lgkmcnt(2)
    v_add_f32 v24, v24, v40
    v_add_f32 v25, v25, v41
    v_add_f32 v26, v26, v42
    v_add_f32 v27, v27, v43
    v_fma_f32 v64, -v14, v24, v118
    v_fma_f32 v65, -v14, v25, v118
    v_fma_f32 v66, -v14, v26, v118
    v_fma_f32 v67, -v14, v27, v118
    v_fma_f32 v88, v88, v15, v64
    v_fma_f32 v89, v89, v15, v65
    v_fma_f32 v90, v90, v15, v66
    v_fma_f32 v91, v91, v15, v67
    v_fma_f32 v68, v88, s97, v117
    v_fma_f32 v69, v89, s97, v117
    v_fma_f32 v70, v90, s97, v117
    v_fma_f32 v71, v91, s97, v117
    v_min_f32 v68, 0, v68
    v_min_f32 v69, 0, v69
    v_min_f32 v70, 0, v70
    v_min_f32 v71, 0, v71
    v_exp_f32 v68, v68
    v_exp_f32 v69, v69
    v_exp_f32 v70, v70
    v_exp_f32 v71, v71
    v_max_f32 v88, s96, v88
    v_max_f32 v89, s96, v89
    v_max_f32 v90, s96, v90
    v_max_f32 v91, s96, v91
    v_add_f32 v88, v88, v68
    v_add_f32 v89, v89, v69
    v_add_f32 v90, v90, v70
    v_add_f32 v91, v91, v71
    v_cvt_pk_bf16_f32 v52, v88, v89
    v_cvt_pk_bf16_f32 v53, v90, v91
    s_waitcnt lgkmcnt(0)
    v_add_f32 v28, v28, v44
    v_add_f32 v29, v29, v45
    v_add_f32 v30, v30, v46
    v_add_f32 v31, v31, v47
    v_fma_f32 v64, -v14, v28, v118
    v_fma_f32 v65, -v14, v29, v118
    v_fma_f32 v66, -v14, v30, v118
    v_fma_f32 v67, -v14, v31, v118
    v_fma_f32 v92, v92, v15, v64
    v_fma_f32 v93, v93, v15, v65
    v_fma_f32 v94, v94, v15, v66
    v_fma_f32 v95, v95, v15, v67
    v_fma_f32 v68, v92, s97, v117
    v_fma_f32 v69, v93, s97, v117
    v_fma_f32 v70, v94, s97, v117
    v_fma_f32 v71, v95, s97, v117
    v_min_f32 v68, 0, v68
    v_min_f32 v69, 0, v69
    v_min_f32 v70, 0, v70
    v_min_f32 v71, 0, v71
    v_exp_f32 v68, v68
    v_exp_f32 v69, v69
    v_exp_f32 v70, v70
    v_exp_f32 v71, v71
    v_max_f32 v92, s96, v92
    v_max_f32 v93, s96, v93
    v_max_f32 v94, s96, v94
    v_max_f32 v95, s96, v95
    v_add_f32 v92, v92, v68
    v_add_f32 v93, v93, v69
    v_add_f32 v94, v94, v70
    v_add_f32 v95, v95, v71
    v_cvt_pk_bf16_f32 v54, v92, v93
    v_cvt_pk_bf16_f32 v55, v94, v95
    v_cndmask_b32 v54, 0, v54, vcc
    v_cndmask_b32 v55, 0, v55, vcc
    buffer_store_dwordx4 v[52:55], v112, s[44:47], s91 offen offset:512 sc1
    s_lshl_b32 s88, s65, 4
    s_lshl_b32 s89, s66, 2
    s_add_u32 s88, s88, s89
    s_add_u32 s88, s88, s67
    v_mov_b32 v112, 0
    v_mov_b32 v113, 1
    s_waitcnt vmcnt(0)
    s_mov_b64 exec, 1
    buffer_store_dword v113, v112, s[4:7], s88 offen offset:512
    s_mov_b64 exec, -1
    s_cmp_lt_u32 s65, 28
    s_cbranch_scc1 L_sequential_preLN__linear_attn_block__dense_activation_gelu__prompt_kernel_43
    v_mov_b32 v112, 163712
    s_mov_b32 s99, 0
    s_branch L_sequential_preLN__linear_attn_block__dense_activation_gelu__prompt_kernel_44_f
L_sequential_preLN__linear_attn_block__dense_activation_gelu__prompt_kernel_44:
    s_cmp_lg_u32 s99, 100
    s_cbranch_scc1 L_sequential_preLN__linear_attn_block__dense_activation_gelu__prompt_kernel_44_p
    s_lshl_b32 s88, s65, 4
    s_lshl_b32 s89, s66, 2
    s_add_u32 s88, s88, s89
    s_add_u32 s88, s88, s67
    v_mov_b32 v113, 0
    v_mov_b32 v114, 1
    s_mov_b64 exec, 1
    buffer_store_dword v114, v113, s[44:47], s88 offen offset:2560 sc1
    s_mov_b64 exec, -1
L_sequential_preLN__linear_attn_block__dense_activation_gelu__prompt_kernel_44_p:
    s_sleep 1
L_sequential_preLN__linear_attn_block__dense_activation_gelu__prompt_kernel_44_f:
    ds_read_b32 v113, v112
    s_add_u32 s99, s99, 1
    s_waitcnt lgkmcnt(0)
    v_readfirstlane_b32 s98, v113
    s_cmp_gt_u32 s99, 800000
    s_cbranch_scc1 L_sequential_preLN__linear_attn_block__dense_activation_gelu__prompt_kernel_44_x
    s_cmp_lt_u32 s98, 8
    s_cbranch_scc1 L_sequential_preLN__linear_attn_block__dense_activation_gelu__prompt_kernel_44
L_sequential_preLN__linear_attn_block__dense_activation_gelu__prompt_kernel_44_x:
    v_and_b32 v124, 31, v1
    v_lshlrev_b32 v124, 5, v124
    s_lshl_b32 s3, s64, 10
    s_add_u32 s3, s3, 102400
    buffer_load_dword v125, v124, s[44:47], s3 offen sc1
    s_waitcnt vmcnt(0)
    s_mov_b32 s99, 0
    s_branch L_sequential_preLN__linear_attn_block__dense_activation_gelu__prompt_kernel_45_c
L_sequential_preLN__linear_attn_block__dense_activation_gelu__prompt_kernel_45:
    buffer_load_dword v125, v124, s[44:47], s3 offen sc1
    s_add_u32 s99, s99, 1
    s_waitcnt vmcnt(0)
L_sequential_preLN__linear_attn_block__dense_activation_gelu__prompt_kernel_45_c:
    v_cmp_ne_u32 s[94:95], 0, v125
    s_cmp_gt_u32 s99, 200000
    s_cbranch_scc1 L_sequential_preLN__linear_attn_block__dense_activation_gelu__prompt_kernel_45_x
    s_cmp_eq_u64 s[94:95], -1
    s_cbranch_scc0 L_sequential_preLN__linear_attn_block__dense_activation_gelu__prompt_kernel_45
L_sequential_preLN__linear_attn_block__dense_activation_gelu__prompt_kernel_45_x:
    s_getreg_b32 s88, hwreg(HW_REG_XCC_ID, 0, 4)
    s_or_b32 s88, s88, 0x80
    v_cmp_eq_u32 s[94:95], s88, v125
    s_nop 0
    s_cmp_eq_u64 s[94:95], -1
    s_cselect_b32 s70, 0, 268435456
    s_lshl_b32 s88, s65, 4
    s_lshl_b32 s89, s66, 2
    s_add_u32 s88, s88, s89
    s_add_u32 s88, s88, s67
    v_mov_b32 v112, 0
    v_mov_b32 v113, 1
    s_mov_b64 exec, 1
    buffer_store_dword v113, v112, s[68:71], s88 offen offset:2560 sc1
    s_mov_b64 exec, -1
    s_branch LendX_sequential_preLN__linear_attn_block__dense_activation_gelu__prompt_kernel
L_sequential_preLN__linear_attn_block__dense_activation_gelu__prompt_kernel_43:
    s_cmp_ge_u32 s65, 14
    s_cselect_b32 s83, 1, 0
    s_cselect_b32 s89, 14, 0
    s_sub_u32 s76, s65, s89
    s_lshr_b32 s88, s66, 1
    s_and_b32 s89, s66, 1
    s_lshl_b32 s78, s89, 4
    s_lshl_b32 s79, s88, 2
    s_add_u32 s78, s78, s79
    s_lshl_b32 s79, s88, 3
    s_lshl_b32 s89, s89, 2
    s_add_u32 s79, s79, s89
    s_mul_i32 s78, s78, 3584
    s_mul_i32 s79, s79, 3584
    s_lshl_b32 s88, s76, 8
    s_add_u32 s78, s78, s88
    s_add_u32 s79, s79, s88
    s_lshl_b32 s82, s66, 10
    v_lshrrev_b32 v112, 4, v1
    v_mul_u32_u24 v2, 3584, v112
    v_bfe_u32 v113, v1, 2, 2
    v_xor_b32 v113, v113, v112
    v_lshl_add_u32 v2, v113, 6, v2
    v_and_b32 v113, 3, v1
    v_lshl_add_u32 v2, v113, 4, v2
    s_lshl_b32 s88, s83, 1
    s_add_u32 s88, s88, 0
    s_and_b32 s88, s88, 3
    s_mul_i32 s88, s88, 401408
    s_add_u32 s48, s78, s88
    s_add_u32 s52, s79, s88
    s_lshl_b32 s88, s83, 1
    s_add_u32 s88, s88, 1
    s_and_b32 s88, s88, 3
    s_mul_i32 s88, s88, 401408
    s_add_u32 s49, s78, s88
    s_add_u32 s53, s79, s88
    s_lshl_b32 s88, s83, 1
    s_add_u32 s88, s88, 2
    s_and_b32 s88, s88, 3
    s_mul_i32 s88, s88, 401408
    s_add_u32 s50, s78, s88
    s_add_u32 s54, s79, s88
    s_lshl_b32 s88, s83, 1
    s_add_u32 s88, s88, 3
    s_and_b32 s88, s88, 3
    s_mul_i32 s88, s88, 401408
    s_add_u32 s51, s78, s88
    s_add_u32 s55, s79, s88
    v_lshrrev_b32 v112, 5, v1
    v_bfe_u32 v113, v1, 2, 2
    v_lshl_add_u32 v112, v112, 3, v113
    v_lshlrev_b32 v4, 8, v112
    v_xor_b32 v113, s66, v113
    v_lshl_add_u32 v4, v113, 6, v4
    v_bfe_u32 v113, v1, 4, 1
    v_lshl_add_u32 v4, v113, 5, v4
    v_and_b32 v113, 1, v1
    v_lshl_add_u32 v4, v113, 4, v4
    v_bfe_u32 v113, v1, 1, 1
    v_lshl_add_u32 v4, v113, 3, v4
    v_add_u32 v3, 32768, v4
    v_add_u32 v4, 106496, v4
    v_lshrrev_b32 v112, 4, v1
    v_xor_b32 v112, v112, v1
    v_and_b32 v112, 1, v112
    v_cmp_eq_u32 vcc, 0, v112
    v_mov_b32 v112, 0x3f803f80
    s_nop 0
    v_cndmask_b32 v16, 0, v112, vcc
    v_cndmask_b32 v17, 0, v112, vcc
    v_cndmask_b32 v18, 0, v112, vcc
    v_cndmask_b32 v19, 0, v112, vcc
    v_and_b32 v112, 0x13, v1
    v_bfe_u32 v113, v1, 2, 1
    v_lshl_add_u32 v112, v113, 3, v112
    v_bfe_u32 v113, v1, 3, 1
    v_lshl_add_u32 v112, v113, 2, v112
    v_lshlrev_b32 v112, 1, v112
    s_lshl_b32 s88, s76, 8
    s_lshl_b32 s89, s66, 6
    s_add_u32 s88, s88, s89
    buffer_load_ushort v116, v112, s[24:27], s88 offen
    s_lshl_b32 s75, s64, 1
    s_add_u32 s75, s75, s83
    s_mul_i32 s88, s75, 448
    s_lshl_b32 s89, s76, 3
    s_add_u32 s88, s88, s89
    s_lshl_b32 s89, s66, 1
    s_add_u32 s88, s88, s89
    s_lshl_b32 s88, s88, 10
    s_add_u32 s79, s88, 6291456
    s_add_u32 s88, s76, 0
    s_and_b32 s88, s88, 3
    s_mul_i32 s88, s88, 114688
    s_add_u32 s56, s79, s88
    s_add_u32 s88, s76, 1
    s_and_b32 s88, s88, 3
    s_mul_i32 s88, s88, 114688
    s_add_u32 s57, s79, s88
    s_add_u32 s88, s76, 2
    s_and_b32 s88, s88, 3
    s_mul_i32 s88, s88, 114688
    s_add_u32 s58, s79, s88
    s_add_u32 s88, s76, 3
    s_and_b32 s88, s88, 3
    s_mul_i32 s88, s88, 114688
    s_add_u32 s59, s79, s88
    s_waitcnt lgkmcnt(0)
    v_mov_b32 v112, 163716
    v_mov_b32 v113, 1
    s_mov_b64 exec, 1
    ds_add_u32 v112, v113
    s_mov_b64 exec, -1
    v_mov_b32 v112, 163716
    s_mov_b32 s99, 0
    s_branch L_sequential_preLN__linear_attn_block__dense_activation_gelu__prompt_kernel_46_f
L_sequential_preLN__linear_attn_block__dense_activation_gelu__prompt_kernel_46:
    s_sleep 1
L_sequential_preLN__linear_attn_block__dense_activation_gelu__prompt_kernel_46_f:
    ds_read_b32 v113, v112
    s_add_u32 s99, s99, 1
    s_waitcnt lgkmcnt(0)
    v_readfirstlane_b32 s98, v113
    s_cmp_gt_u32 s99, 800000
    s_cbranch_scc1 L_sequential_preLN__linear_attn_block__dense_activation_gelu__prompt_kernel_46_x
    s_cmp_lt_u32 s98, 4
    s_cbranch_scc1 L_sequential_preLN__linear_attn_block__dense_activation_gelu__prompt_kernel_46
L_sequential_preLN__linear_attn_block__dense_activation_gelu__prompt_kernel_46_x:
    v_mov_b32 v112, 163712
    s_mov_b32 s99, 0
    s_branch L_sequential_preLN__linear_attn_block__dense_activation_gelu__prompt_kernel_47_f
L_sequential_preLN__linear_attn_block__dense_activation_gelu__prompt_kernel_47:
    s_cmp_lg_u32 s99, 100
    s_cbranch_scc1 L_sequential_preLN__linear_attn_block__dense_activation_gelu__prompt_kernel_47_p
    s_lshl_b32 s88, s65, 4
    s_lshl_b32 s89, s66, 2
    s_add_u32 s88, s88, s89
    s_add_u32 s88, s88, s67
    v_mov_b32 v113, 0
    v_mov_b32 v114, 1
    s_mov_b64 exec, 1
    buffer_store_dword v114, v113, s[44:47], s88 offen offset:2560 sc1
    s_mov_b64 exec, -1
L_sequential_preLN__linear_attn_block__dense_activation_gelu__prompt_kernel_47_p:
    s_sleep 1
L_sequential_preLN__linear_attn_block__dense_activation_gelu__prompt_kernel_47_f:
    ds_read_b32 v113, v112
    s_add_u32 s99, s99, 1
    s_waitcnt lgkmcnt(0)
    v_readfirstlane_b32 s98, v113
    s_cmp_gt_u32 s99, 800000
    s_cbranch_scc1 L_sequential_preLN__linear_attn_block__dense_activation_gelu__prompt_kernel_47_x
    s_cmp_lt_u32 s98, 4
    s_cbranch_scc1 L_sequential_preLN__linear_attn_block__dense_activation_gelu__prompt_kernel_47
L_sequential_preLN__linear_attn_block__dense_activation_gelu__prompt_kernel_47_x:
    s_add_u32 m0, s82, 106496
    s_nop 0
    buffer_load_dwordx4 v2, s[20:23], s48 offen  lds
    s_add_u32 m0, s82, 110592
    s_add_u32 s88, s48, 28672
    buffer_load_dwordx4 v2, s[20:23], s88 offen  lds
    s_add_u32 m0, s82, 114688
    s_add_u32 s88, s48, 114688
    buffer_load_dwordx4 v2, s[20:23], s88 offen  lds
    s_add_u32 m0, s82, 118784
    s_add_u32 s88, s48, 143360
    buffer_load_dwordx4 v2, s[20:23], s88 offen  lds
    s_add_u32 m0, s82, 122880
    s_add_u32 s88, s48, 229376
    buffer_load_dwordx4 v2, s[20:23], s88 offen  lds
    s_add_u32 m0, s82, 126976
    s_add_u32 s88, s48, 258048
    buffer_load_dwordx4 v2, s[20:23], s88 offen  lds
    s_add_u32 m0, s82, 131072
    s_add_u32 s88, s52, 344064
    buffer_load_dwordx4 v2, s[20:23], s88 offen  lds
    s_add_u32 m0, s82, 135168
    s_nop 0
    buffer_load_dwordx4 v2, s[20:23], s49 offen  lds
    s_add_u32 m0, s82, 139264
    s_add_u32 s88, s49, 28672
    buffer_load_dwordx4 v2, s[20:23], s88 offen  lds
    s_add_u32 m0, s82, 143360
    s_add_u32 s88, s49, 114688
    buffer_load_dwordx4 v2, s[20:23], s88 offen  lds
    s_add_u32 m0, s82, 147456
    s_add_u32 s88, s49, 143360
    buffer_load_dwordx4 v2, s[20:23], s88 offen  lds
    s_add_u32 m0, s82, 151552
    s_add_u32 s88, s49, 229376
    buffer_load_dwordx4 v2, s[20:23], s88 offen  lds
    s_add_u32 m0, s82, 155648
    s_add_u32 s88, s49, 258048
    buffer_load_dwordx4 v2, s[20:23], s88 offen  lds
    s_waitcnt vmcnt(0)
    s_waitcnt lgkmcnt(0)
    v_mov_b32 v112, 163716
    v_mov_b32 v113, 1
    s_mov_b64 exec, 1
    ds_add_u32 v112, v113
    s_mov_b64 exec, -1
    v_mov_b32 v112, 163716
    s_mov_b32 s99, 0
    s_branch L_sequential_preLN__linear_attn_block__dense_activation_gelu__prompt_kernel_48_f
L_sequential_preLN__linear_attn_block__dense_activation_gelu__prompt_kernel_48:
    s_sleep 1
L_sequential_preLN__linear_attn_block__dense_activation_gelu__prompt_kernel_48_f:
    ds_read_b32 v113, v112
    s_add_u32 s99, s99, 1
    s_waitcnt lgkmcnt(0)
    v_readfirstlane_b32 s98, v113
    s_cmp_gt_u32 s99, 800000
    s_cbranch_scc1 L_sequential_preLN__linear_attn_block__dense_activation_gelu__prompt_kernel_48_x
    s_cmp_lt_u32 s98, 8
    s_cbranch_scc1 L_sequential_preLN__linear_attn_block__dense_activation_gelu__prompt_kernel_48
L_sequential_preLN__linear_attn_block__dense_activation_gelu__prompt_kernel_48_x:
    ds_read_b64_tr_b16 a[0:1], v4 offset:0
    ds_read_b64_tr_b16 a[2:3], v4 offset:1024
    ds_read_b64_tr_b16 a[4:5], v4 offset:4096
    ds_read_b64_tr_b16 a[6:7], v4 offset:5120
    ds_read_b64_tr_b16 a[8:9], v4 offset:8192
    ds_read_b64_tr_b16 a[10:11], v4 offset:9216
    ds_read_b64_tr_b16 a[12:13], v4 offset:12288
    ds_read_b64_tr_b16 a[14:15], v4 offset:13312
    s_waitcnt lgkmcnt(6)
    v_mfma_f32_16x16x32_bf16 v[20:23], v[16:19], a[0:3], 0
    ds_read_b64_tr_b16 a[16:17], v4 offset:16384
    ds_read_b64_tr_b16 a[18:19], v4 offset:17408
    s_waitcnt lgkmcnt(6)
    v_mfma_f32_16x16x32_bf16 v[20:23], v[16:19], a[4:7], v[20:23]
    ds_read_b64_tr_b16 a[20:21], v4 offset:20480
    ds_read_b64_tr_b16 a[22:23], v4 offset:21504
    s_waitcnt lgkmcnt(6)
    v_mfma_f32_16x16x32_bf16 v[20:23], v[16:19], a[8:11], v[20:23]
    ds_read_b64_tr_b16 a[24:25], v4 offset:24576
    ds_read_b64_tr_b16 a[26:27], v4 offset:25600
    s_waitcnt lgkmcnt(6)
    v_mfma_f32_16x16x32_bf16 v[20:23], v[16:19], a[12:15], v[20:23]
    ds_read_b64_tr_b16 a[28:29], v4 offset:28672
    ds_read_b64_tr_b16 a[30:31], v4 offset:29696
    s_waitcnt lgkmcnt(6)
    v_mfma_f32_16x16x32_bf16 v[20:23], v[16:19], a[16:19], v[20:23]
    ds_read_b64_tr_b16 a[32:33], v4 offset:32768
    ds_read_b64_tr_b16 a[34:35], v4 offset:33792
    s_waitcnt lgkmcnt(6)
    v_mfma_f32_16x16x32_bf16 v[20:23], v[16:19], a[20:23], v[20:23]
    ds_read_b64_tr_b16 a[36:37], v4 offset:36864
    ds_read_b64_tr_b16 a[38:39], v4 offset:37888
    s_waitcnt lgkmcnt(6)
    v_mfma_f32_16x16x32_bf16 v[20:23], v[16:19], a[24:27], v[20:23]
    ds_read_b64_tr_b16 a[40:41], v4 offset:40960
    ds_read_b64_tr_b16 a[42:43], v4 offset:41984
    s_waitcnt lgkmcnt(6)
    v_mfma_f32_16x16x32_bf16 v[20:23], v[16:19], a[28:31], v[20:23]
    ds_read_b64_tr_b16 a[44:45], v4 offset:45056
    ds_read_b64_tr_b16 a[46:47], v4 offset:46080
    s_waitcnt lgkmcnt(6)
    v_mfma_f32_16x16x32_bf16 v[20:23], v[16:19], a[32:35], v[20:23]
    ds_read_b64_tr_b16 a[48:49], v4 offset:49152
    ds_read_b64_tr_b16 a[50:51], v4 offset:50176
    s_waitcnt lgkmcnt(6)
    v_mfma_f32_16x16x32_bf16 v[20:23], v[16:19], a[36:39], v[20:23]
    s_waitcnt lgkmcnt(4)
    v_mfma_f32_16x16x32_bf16 v[20:23], v[16:19], a[40:43], v[20:23]
    s_waitcnt lgkmcnt(2)
    v_mfma_f32_16x16x32_bf16 v[20:23], v[16:19], a[44:47], v[20:23]
    s_waitcnt lgkmcnt(0)
    v_mfma_f32_16x16x32_bf16 v[20:23], v[16:19], a[48:51], v[20:23]
    v_mov_b32 v112, 163712
    s_mov_b32 s99, 0
    s_branch L_sequential_preLN__linear_attn_block__dense_activation_gelu__prompt_kernel_49_f
L_sequential_preLN__linear_attn_block__dense_activation_gelu__prompt_kernel_49:
    s_cmp_lg_u32 s99, 100
    s_cbranch_scc1 L_sequential_preLN__linear_attn_block__dense_activation_gelu__prompt_kernel_49_p
    s_lshl_b32 s88, s65, 4
    s_lshl_b32 s89, s66, 2
    s_add_u32 s88, s88, s89
    s_add_u32 s88, s88, s67
    v_mov_b32 v113, 0
    v_mov_b32 v114, 1
    s_mov_b64 exec, 1
    buffer_store_dword v114, v113, s[44:47], s88 offen offset:2560 sc1
    s_mov_b64 exec, -1
L_sequential_preLN__linear_attn_block__dense_activation_gelu__prompt_kernel_49_p:
    s_sleep 1
L_sequential_preLN__linear_attn_block__dense_activation_gelu__prompt_kernel_49_f:
    ds_read_b32 v113, v112
    s_add_u32 s99, s99, 1
    s_waitcnt lgkmcnt(0)
    v_readfirstlane_b32 s98, v113
    s_cmp_gt_u32 s99, 800000
    s_cbranch_scc1 L_sequential_preLN__linear_attn_block__dense_activation_gelu__prompt_kernel_49_x
    s_cmp_lt_u32 s98, 8
    s_cbranch_scc1 L_sequential_preLN__linear_attn_block__dense_activation_gelu__prompt_kernel_49
L_sequential_preLN__linear_attn_block__dense_activation_gelu__prompt_kernel_49_x:
    s_add_u32 m0, s82, 32768
    s_add_u32 s88, s53, 344064
    buffer_load_dwordx4 v2, s[20:23], s88 offen  lds
    s_add_u32 m0, s82, 36864
    s_nop 0
    buffer_load_dwordx4 v2, s[20:23], s50 offen  lds
    s_add_u32 m0, s82, 40960
    s_add_u32 s88, s50, 28672
    buffer_load_dwordx4 v2, s[20:23], s88 offen  lds
    s_add_u32 m0, s82, 45056
    s_add_u32 s88, s50, 114688
    buffer_load_dwordx4 v2, s[20:23], s88 offen  lds
    s_add_u32 m0, s82, 49152
    s_add_u32 s88, s50, 143360
    buffer_load_dwordx4 v2, s[20:23], s88 offen  lds
    s_add_u32 m0, s82, 53248
    s_add_u32 s88, s50, 229376
    buffer_load_dwordx4 v2, s[20:23], s88 offen  lds
    s_add_u32 m0, s82, 57344
    s_add_u32 s88, s50, 258048
    buffer_load_dwordx4 v2, s[20:23], s88 offen  lds
    s_add_u32 m0, s82, 61440
    s_add_u32 s88, s54, 344064
    buffer_load_dwordx4 v2, s[20:23], s88 offen  lds
    s_add_u32 m0, s82, 65536
    s_nop 0
    buffer_load_dwordx4 v2, s[20:23], s51 offen  lds
    s_add_u32 m0, s82, 69632
    s_add_u32 s88, s51, 28672
    buffer_load_dwordx4 v2, s[20:23], s88 offen  lds
    s_add_u32 m0, s82, 73728
    s_add_u32 s88, s51, 114688
    buffer_load_dwordx4 v2, s[20:23], s88 offen  lds
    s_add_u32 m0, s82, 77824
    s_add_u32 s88, s51, 143360
    buffer_load_dwordx4 v2, s[20:23], s88 offen  lds
    s_add_u32 m0, s82, 81920
    s_add_u32 s88, s51, 229376
    buffer_load_dwordx4 v2, s[20:23], s88 offen  lds
    s_add_u32 m0, s82, 86016
    s_add_u32 s88, s51, 258048
    buffer_load_dwordx4 v2, s[20:23], s88 offen  lds
    s_add_u32 m0, s82, 90112
    s_add_u32 s88, s55, 344064
    buffer_load_dwordx4 v2, s[20:23], s88 offen  lds
    v_and_b32 v124, 31, v1
    v_lshlrev_b32 v124, 5, v124
    s_lshl_b32 s3, s64, 10
    s_add_u32 s3, s3, 102400
    buffer_load_dword v125, v124, s[44:47], s3 offen sc1
    s_waitcnt vmcnt(0)
    s_waitcnt lgkmcnt(0)
    v_mov_b32 v112, 163716
    v_mov_b32 v113, 1
    s_mov_b64 exec, 1
    ds_add_u32 v112, v113
    s_mov_b64 exec, -1
    v_mov_b32 v112, 163716
    s_mov_b32 s99, 0
    s_branch L_sequential_preLN__linear_attn_block__dense_activation_gelu__prompt_kernel_50_f
L_sequential_preLN__linear_attn_block__dense_activation_gelu__prompt_kernel_50:
    s_sleep 1
L_sequential_preLN__linear_attn_block__dense_activation_gelu__prompt_kernel_50_f:
    ds_read_b32 v113, v112
    s_add_u32 s99, s99, 1
    s_waitcnt lgkmcnt(0)
    v_readfirstlane_b32 s98, v113
    s_cmp_gt_u32 s99, 800000
    s_cbranch_scc1 L_sequential_preLN__linear_attn_block__dense_activation_gelu__prompt_kernel_50_x
    s_cmp_lt_u32 s98, 12
    s_cbranch_scc1 L_sequential_preLN__linear_attn_block__dense_activation_gelu__prompt_kernel_50
L_sequential_preLN__linear_attn_block__dense_activation_gelu__prompt_kernel_50_x:
    ds_read_b64_tr_b16 a[52:53], v3 offset:0
    ds_read_b64_tr_b16 a[54:55], v3 offset:1024
    ds_read_b64_tr_b16 a[56:57], v3 offset:4096
    ds_read_b64_tr_b16 a[58:59], v3 offset:5120
    ds_read_b64_tr_b16 a[60:61], v3 offset:8192
    ds_read_b64_tr_b16 a[62:63], v3 offset:9216
    ds_read_b64_tr_b16 a[64:65], v3 offset:12288
    ds_read_b64_tr_b16 a[66:67], v3 offset:13312
    s_waitcnt lgkmcnt(6)
    v_mfma_f32_16x16x32_bf16 v[20:23], v[16:19], a[52:55], v[20:23]
    ds_read_b64_tr_b16 a[68:69], v3 offset:16384
    ds_read_b64_tr_b16 a[70:71], v3 offset:17408
    s_waitcnt lgkmcnt(6)
    v_mfma_f32_16x16x32_bf16 v[20:23], v[16:19], a[56:59], v[20:23]
    ds_read_b64_tr_b16 a[72:73], v3 offset:20480
    ds_read_b64_tr_b16 a[74:75], v3 offset:21504
    s_waitcnt lgkmcnt(6)
    v_mfma_f32_16x16x32_bf16 v[20:23], v[16:19], a[60:63], v[20:23]
    ds_read_b64_tr_b16 a[76:77], v3 offset:24576
    ds_read_b64_tr_b16 a[78:79], v3 offset:25600
    s_waitcnt lgkmcnt(6)
    v_mfma_f32_16x16x32_bf16 v[20:23], v[16:19], a[64:67], v[20:23]
    ds_read_b64_tr_b16 a[80:81], v3 offset:28672
    ds_read_b64_tr_b16 a[82:83], v3 offset:29696
    s_waitcnt lgkmcnt(6)
    v_mfma_f32_16x16x32_bf16 v[20:23], v[16:19], a[68:71], v[20:23]
    ds_read_b64_tr_b16 a[84:85], v3 offset:32768
    ds_read_b64_tr_b16 a[86:87], v3 offset:33792
    s_waitcnt lgkmcnt(6)
    v_mfma_f32_16x16x32_bf16 v[20:23], v[16:19], a[72:75], v[20:23]
    ds_read_b64_tr_b16 a[88:89], v3 offset:36864
    ds_read_b64_tr_b16 a[90:91], v3 offset:37888
    s_waitcnt lgkmcnt(6)
    v_mfma_f32_16x16x32_bf16 v[20:23], v[16:19], a[76:79], v[20:23]
    ds_read_b64_tr_b16 a[92:93], v3 offset:40960
    ds_read_b64_tr_b16 a[94:95], v3 offset:41984
    s_waitcnt lgkmcnt(6)
    v_mfma_f32_16x16x32_bf16 v[20:23], v[16:19], a[80:83], v[20:23]
    ds_read_b64_tr_b16 a[96:97], v3 offset:45056
    ds_read_b64_tr_b16 a[98:99], v3 offset:46080
    s_waitcnt lgkmcnt(6)
    v_mfma_f32_16x16x32_bf16 v[20:23], v[16:19], a[84:87], v[20:23]
    ds_read_b64_tr_b16 a[100:101], v3 offset:49152
    ds_read_b64_tr_b16 a[102:103], v3 offset:50176
    s_waitcnt lgkmcnt(6)
    v_mfma_f32_16x16x32_bf16 v[20:23], v[16:19], a[88:91], v[20:23]
    ds_read_b64_tr_b16 a[104:105], v3 offset:53248
    ds_read_b64_tr_b16 a[106:107], v3 offset:54272
    s_waitcnt lgkmcnt(6)
    v_mfma_f32_16x16x32_bf16 v[20:23], v[16:19], a[92:95], v[20:23]
    ds_read_b64_tr_b16 a[108:109], v3 offset:57344
    ds_read_b64_tr_b16 a[110:111], v3 offset:58368
    s_waitcnt lgkmcnt(6)
    v_mfma_f32_16x16x32_bf16 v[20:23], v[16:19], a[96:99], v[20:23]
    s_waitcnt lgkmcnt(4)
    v_mfma_f32_16x16x32_bf16 v[20:23], v[16:19], a[100:103], v[20:23]
    s_waitcnt lgkmcnt(2)
    v_mfma_f32_16x16x32_bf16 v[20:23], v[16:19], a[104:107], v[20:23]
    s_waitcnt lgkmcnt(0)
    v_mfma_f32_16x16x32_bf16 v[20:23], v[16:19], a[108:111], v[20:23]
    v_mov_b32 v112, 163748
    v_mov_b32 v113, 1
    s_mov_b64 exec, 1
    ds_add_u32 v112, v113
    s_mov_b64 exec, -1
    s_mov_b32 s99, 0
    s_branch L_sequential_preLN__linear_attn_block__dense_activation_gelu__prompt_kernel_51_c
L_sequential_preLN__linear_attn_block__dense_activation_gelu__prompt_kernel_51:
    buffer_load_dword v125, v124, s[44:47], s3 offen sc1
    s_add_u32 s99, s99, 1
    s_waitcnt vmcnt(0)
L_sequential_preLN__linear_attn_block__dense_activation_gelu__prompt_kernel_51_c:
    v_cmp_ne_u32 s[94:95], 0, v125
    s_cmp_gt_u32 s99, 200000
    s_cbranch_scc1 L_sequential_preLN__linear_attn_block__dense_activation_gelu__prompt_kernel_51_x
    s_cmp_eq_u64 s[94:95], -1
    s_cbranch_scc0 L_sequential_preLN__linear_attn_block__dense_activation_gelu__prompt_kernel_51
L_sequential_preLN__linear_attn_block__dense_activation_gelu__prompt_kernel_51_x:
    s_getreg_b32 s88, hwreg(HW_REG_XCC_ID, 0, 4)
    s_or_b32 s88, s88, 0x80
    v_cmp_eq_u32 s[94:95], s88, v125
    s_nop 0
    s_cmp_eq_u64 s[94:95], -1
    s_cselect_b32 s70, 0, 268435456
    s_lshl_b32 s88, s65, 4
    s_lshl_b32 s89, s66, 2
    s_add_u32 s88, s88, s89
    s_add_u32 s88, s88, s67
    v_mov_b32 v112, 0
    v_mov_b32 v113, 1
    s_mov_b64 exec, 1
    buffer_store_dword v113, v112, s[68:71], s88 offen offset:2560 sc1
    s_mov_b64 exec, -1
    v_bfe_u32 v112, v1, 4, 1
    v_cmp_eq_u32 vcc, 1, v112
    s_nop 1
    v_cndmask_b32 v112, v20, v21, vcc
    v_cvt_pk_bf16_f32 v113, v112, v112
    v_and_b32 v114, 0xffff0000, v113
    v_sub_f32 v114, v112, v114
    v_cvt_pk_bf16_f32 v114, v112, v114
    v_and_b32 v113, 0xffff, v113
    v_lshl_or_b32 v113, v116, 16, v113
    v_cmp_gt_u32 vcc, 32, v1
    s_nop 1
    v_cndmask_b32 v114, 0, v114, vcc
    v_cndmask_b32 v113, 0, v113, vcc
    v_cndmask_b32 v116, 0, v116, vcc
    v_accvgpr_write_b32 a112, v114
    v_accvgpr_write_b32 a113, v113
    v_accvgpr_write_b32 a114, v116
    v_accvgpr_write_b32 a115, 0
    v_lshlrev_b32 v6, 4, v1
    v_add_u32 v7, 59392, v6
    v_and_b32 v9, 31, v1
    v_lshlrev_b32 v9, 4, v9
    v_add_u32 v9, 118784, v9
    v_mov_b32 v8, 163712
    v_mov_b32 v10, 1
    s_mul_i32 s88, s75, 114688
    s_mul_i32 s77, s66, 7168
    s_lshl_b32 s89, s83, 1
    s_add_u32 s89, s89, s66
    s_and_b32 s89, s89, 3
    s_mul_i32 s89, s89, 7168
    s_add_u32 s78, s88, s89
    s_and_b32 s88, s76, 3
    s_mul_i32 s88, s88, 28672
    s_add_u32 s78, s78, s88
    s_add_u32 s78, s78, 3145728
    s_lshl_b32 s88, s83, 8
    s_add_u32 s92, s67, s88
    v_lshlrev_b32 v3, 2, v1
    s_mov_b64 s[96:97], -1
    v_mov_b32 v112, 163712
    s_mov_b32 s99, 0
    s_branch L_sequential_preLN__linear_attn_block__dense_activation_gelu__prompt_kernel_52_f
L_sequential_preLN__linear_attn_block__dense_activation_gelu__prompt_kernel_52:
    s_sleep 1
L_sequential_preLN__linear_attn_block__dense_activation_gelu__prompt_kernel_52_f:
    ds_read_b32 v113, v112
    s_add_u32 s99, s99, 1
    s_waitcnt lgkmcnt(0)
    v_readfirstlane_b32 s98, v113
    s_cmp_gt_u32 s99, 800000
    s_cbranch_scc1 L_sequential_preLN__linear_attn_block__dense_activation_gelu__prompt_kernel_52_x
    s_cmp_lt_u32 s98, 12
    s_cbranch_scc1 L_sequential_preLN__linear_attn_block__dense_activation_gelu__prompt_kernel_52
L_sequential_preLN__linear_attn_block__dense_activation_gelu__prompt_kernel_52_x:
    s_mov_b32 s99, 0
    s_branch L_sequential_preLN__linear_attn_block__dense_activation_gelu__prompt_kernel_53_f
L_sequential_preLN__linear_attn_block__dense_activation_gelu__prompt_kernel_53:
    s_sleep 1
L_sequential_preLN__linear_attn_block__dense_activation_gelu__prompt_kernel_53_f:
    buffer_load_dword v112, v3, s[44:47], s92 offen offset:1024 sc1
    s_waitcnt vmcnt(0)
L_sequential_preLN__linear_attn_block__dense_activation_gelu__prompt_kernel_53_c:
    s_add_u32 s99, s99, 1
    v_cmp_ne_u32 vcc, 0, v112
    s_nop 0
    s_andn2_b64 s[94:95], s[96:97], vcc
    s_cmp_eq_u64 s[94:95], 0
    s_cbranch_scc1 L_sequential_preLN__linear_attn_block__dense_activation_gelu__prompt_kernel_53_x
    s_cmp_lt_u32 s99, 32
    s_cbranch_scc1 L_sequential_preLN__linear_attn_block__dense_activation_gelu__prompt_kernel_53
L_sequential_preLN__linear_attn_block__dense_activation_gelu__prompt_kernel_53_s:
    buffer_load_dword v112, v3, s[44:47], s92 offen offset:1024 sc1
    buffer_load_dword v114, v3, s[44:47], s92 offen offset:3072 sc1
    s_add_u32 s99, s99, 1
    s_waitcnt vmcnt(0)
    v_or_b32 v112, v112, v114
    v_cmp_ne_u32 vcc, 0, v112
    s_nop 0
    s_andn2_b64 s[94:95], s[96:97], vcc
    s_cmp_eq_u64 s[94:95], 0
    s_cbranch_scc1 L_sequential_preLN__linear_attn_block__dense_activation_gelu__prompt_kernel_53_x
    s_cmp_lt_u32 s99, 200000
    s_cbranch_scc1 L_sequential_preLN__linear_attn_block__dense_activation_gelu__prompt_kernel_53_s
L_sequential_preLN__linear_attn_block__dense_activation_gelu__prompt_kernel_53_x:
    s_add_u32 m0, s77, 0
    s_nop 0
    buffer_load_dwordx4 v6, s[44:47], s78 offen sc1 lds
    buffer_load_dwordx4 v6, s[44:47], s78 offen offset:1024 sc1 lds
    buffer_load_dwordx4 v6, s[44:47], s78 offen offset:2048 sc1 lds
    buffer_load_dwordx4 v6, s[44:47], s78 offen offset:3072 sc1 lds
    s_add_u32 m0, s77, 4096
    s_add_u32 s88, s78, 4096
    buffer_load_dwordx4 v6, s[44:47], s88 offen sc1 lds
    buffer_load_dwordx4 v6, s[44:47], s88 offen offset:1024 sc1 lds
    buffer_load_dwordx4 v6, s[44:47], s88 offen offset:2048 sc1 lds
    s_waitcnt vmcnt(0)
    v_mov_b32 v112, 163720
    v_mov_b32 v113, 1
    s_mov_b64 exec, 1
    ds_add_u32 v112, v113
    s_mov_b64 exec, -1
    v_mov_b32 v112, 163720
    s_mov_b32 s99, 0
    s_branch L_sequential_preLN__linear_attn_block__dense_activation_gelu__prompt_kernel_54_f
L_sequential_preLN__linear_attn_block__dense_activation_gelu__prompt_kernel_54:
    s_sleep 1
L_sequential_preLN__linear_attn_block__dense_activation_gelu__prompt_kernel_54_f:
    ds_read_b32 v113, v112
    s_add_u32 s99, s99, 1
    s_waitcnt lgkmcnt(0)
    v_readfirstlane_b32 s98, v113
    s_cmp_gt_u32 s99, 800000
    s_cbranch_scc1 L_sequential_preLN__linear_attn_block__dense_activation_gelu__prompt_kernel_54_x
    s_cmp_lt_u32 s98, 4
    s_cbranch_scc1 L_sequential_preLN__linear_attn_block__dense_activation_gelu__prompt_kernel_54
L_sequential_preLN__linear_attn_block__dense_activation_gelu__prompt_kernel_54_x:
    ds_read_b128 v[48:51], v6 offset:0
    ds_read_b128 v[52:55], v6 offset:1024
    ds_read_b128 v[56:59], v6 offset:2048
    ds_read_b128 v[60:63], v6 offset:3072
    ds_read_b128 v[64:67], v6 offset:4096
    ds_read_b128 v[68:71], v6 offset:5120
    ds_read_b128 v[72:75], v6 offset:6144
    s_waitcnt lgkmcnt(5)
    v_mfma_f32_32x32x16_bf16 v[16:31], a[0:3], v[48:51], 0
    ds_read_b128 v[76:79], v6 offset:7168
    v_mfma_f32_32x32x16_bf16 v[16:31], a[4:7], v[52:55], v[16:31]
    ds_read_b128 v[48:51], v6 offset:8192
    s_waitcnt lgkmcnt(5)
    v_mfma_f32_32x32x16_bf16 v[16:31], a[8:11], v[56:59], v[16:31]
    ds_read_b128 v[52:55], v6 offset:9216
    v_mfma_f32_32x32x16_bf16 v[16:31], a[12:15], v[60:63], v[16:31]
    ds_read_b128 v[56:59], v6 offset:10240
    s_waitcnt lgkmcnt(5)
    v_mfma_f32_32x32x16_bf16 v[16:31], a[16:19], v[64:67], v[16:31]
    ds_read_b128 v[60:63], v6 offset:11264
    v_mfma_f32_32x32x16_bf16 v[16:31], a[20:23], v[68:71], v[16:31]
    ds_read_b128 v[64:67], v6 offset:12288
    s_waitcnt lgkmcnt(5)
    v_mfma_f32_32x32x16_bf16 v[16:31], a[24:27], v[72:75], v[16:31]
    ds_read_b128 v[68:71], v6 offset:13312
    v_mfma_f32_32x32x16_bf16 v[16:31], a[28:31], v[76:79], v[16:31]
    ds_read_b128 v[72:75], v6 offset:14336
    s_waitcnt lgkmcnt(5)
    v_mfma_f32_32x32x16_bf16 v[16:31], a[32:35], v[48:51], v[16:31]
    ds_read_b128 v[76:79], v6 offset:15360
    v_mfma_f32_32x32x16_bf16 v[16:31], a[36:39], v[52:55], v[16:31]
    ds_read_b128 v[48:51], v6 offset:16384
    s_waitcnt lgkmcnt(5)
    v_mfma_f32_32x32x16_bf16 v[16:31], a[40:43], v[56:59], v[16:31]
    ds_read_b128 v[52:55], v6 offset:17408
    v_mfma_f32_32x32x16_bf16 v[16:31], a[44:47], v[60:63], v[16:31]
    ds_read_b128 v[56:59], v6 offset:18432
    s_waitcnt lgkmcnt(5)
    v_mfma_f32_32x32x16_bf16 v[16:31], a[48:51], v[64:67], v[16:31]
    ds_read_b128 v[60:63], v6 offset:19456
    v_mfma_f32_32x32x16_bf16 v[16:31], a[52:55], v[68:71], v[16:31]
    ds_read_b128 v[64:67], v6 offset:20480
    s_waitcnt lgkmcnt(5)
    v_mfma_f32_32x32x16_bf16 v[16:31], a[56:59], v[72:75], v[16:31]
    ds_read_b128 v[68:71], v6 offset:21504
    v_mfma_f32_32x32x16_bf16 v[16:31], a[60:63], v[76:79], v[16:31]
    ds_read_b128 v[72:75], v6 offset:22528
    s_waitcnt lgkmcnt(5)
    v_mfma_f32_32x32x16_bf16 v[16:31], a[64:67], v[48:51], v[16:31]
    ds_read_b128 v[76:79], v6 offset:23552
    v_mfma_f32_32x32x16_bf16 v[16:31], a[68:71], v[52:55], v[16:31]
    ds_read_b32 v114, v8 offset:12
    ds_read_b128 v[48:51], v6 offset:24576
    s_waitcnt lgkmcnt(6)
    v_mfma_f32_32x32x16_bf16 v[16:31], a[72:75], v[56:59], v[16:31]
    ds_read_b128 v[52:55], v6 offset:25600
    v_mfma_f32_32x32x16_bf16 v[16:31], a[76:79], v[60:63], v[16:31]
    ds_read_b128 v[56:59], v6 offset:26624
    s_waitcnt lgkmcnt(6)
    v_mfma_f32_32x32x16_bf16 v[16:31], a[80:83], v[64:67], v[16:31]
    ds_read_b128 v[60:63], v6 offset:27648
    v_mfma_f32_32x32x16_bf16 v[16:31], a[84:87], v[68:71], v[16:31]
    s_waitcnt lgkmcnt(4)
    v_readfirstlane_b32 s98, v114
    s_nop 0
    s_cmp_ge_u32 s98, 4
    s_cbranch_scc1 L_sequential_preLN__linear_attn_block__dense_activation_gelu__prompt_kernel_55
    v_mov_b32 v112, 163724
    s_mov_b32 s99, 0
    s_branch L_sequential_preLN__linear_attn_block__dense_activation_gelu__prompt_kernel_56_f
L_sequential_preLN__linear_attn_block__dense_activation_gelu__prompt_kernel_56:
    s_sleep 1
L_sequential_preLN__linear_attn_block__dense_activation_gelu__prompt_kernel_56_f:
    ds_read_b32 v113, v112
    s_add_u32 s99, s99, 1
    s_waitcnt lgkmcnt(0)
    v_readfirstlane_b32 s98, v113
    s_cmp_gt_u32 s99, 800000
    s_cbranch_scc1 L_sequential_preLN__linear_attn_block__dense_activation_gelu__prompt_kernel_56_x
    s_cmp_lt_u32 s98, 4
    s_cbranch_scc1 L_sequential_preLN__linear_attn_block__dense_activation_gelu__prompt_kernel_56
L_sequential_preLN__linear_attn_block__dense_activation_gelu__prompt_kernel_56_x:
L_sequential_preLN__linear_attn_block__dense_activation_gelu__prompt_kernel_55:
    ds_read_b128 v[64:67], v6 offset:28672
    ds_read_b128 v[104:107], v9 offset:0
    v_mfma_f32_32x32x16_bf16 v[16:31], a[88:91], v[72:75], v[16:31]
    ds_read_b128 v[68:71], v6 offset:29696
    v_mfma_f32_32x32x16_bf16 v[16:31], a[92:95], v[76:79], v[16:31]
    ds_read_b128 v[72:75], v6 offset:30720
    s_waitcnt lgkmcnt(6)
    v_mfma_f32_32x32x16_bf16 v[16:31], a[96:99], v[48:51], v[16:31]
    ds_read_b128 v[76:79], v6 offset:31744
    v_mfma_f32_32x32x16_bf16 v[16:31], a[100:103], v[52:55], v[16:31]
    ds_read_b128 v[48:51], v6 offset:32768
    s_waitcnt lgkmcnt(6)
    v_mfma_f32_32x32x16_bf16 v[16:31], a[104:107], v[56:59], v[16:31]
    ds_read_b128 v[52:55], v6 offset:33792
    v_mfma_f32_32x32x16_bf16 v[16:31], a[108:111], v[60:63], v[16:31]
    ds_read_b128 v[56:59], v6 offset:34816
    s_waitcnt lgkmcnt(5)
    v_mfma_f32_32x32x16_bf16 v[16:31], a[112:115], v[64:67], v[16:31]
    s_mov_b64 exec, 1
    ds_add_u32 v8, v10 offset:24
    s_mov_b64 exec, -1
    ds_read_b128 v[60:63], v6 offset:35840
    v_mfma_f32_32x32x16_bf16 v[32:47], a[0:3], v[68:71], 0
    ds_read_b128 v[64:67], v6 offset:36864
    s_waitcnt lgkmcnt(6)
    v_mfma_f32_32x32x16_bf16 v[32:47], a[4:7], v[72:75], v[32:47]
    ds_read_b128 v[68:71], v6 offset:37888
    v_mfma_f32_32x32x16_bf16 v[32:47], a[8:11], v[76:79], v[32:47]
    s_nop 1
    v_mul_f32 v80, v16, v16
    v_mul_f32 v81, v17, v17
    v_mul_f32 v82, v18, v18
    v_mul_f32 v83, v19, v19
    v_mul_f32 v84, v20, v20
    ds_read_b128 v[72:75], v6 offset:38912
    s_waitcnt lgkmcnt(6)
    v_mfma_f32_32x32x16_bf16 v[32:47], a[12:15], v[48:51], v[32:47]
    v_mul_f32 v85, v21, v21
    v_mul_f32 v86, v22, v22
    v_mul_f32 v87, v23, v23
    v_fma_f32 v80, v80, v105, v104
    v_fma_f32 v81, v81, v105, v104
    ds_read_b128 v[76:79], v6 offset:39936
    v_mfma_f32_32x32x16_bf16 v[32:47], a[16:19], v[52:55], v[32:47]
    v_fma_f32 v82, v82, v105, v104
    v_fma_f32 v83, v83, v105, v104
    v_fma_f32 v84, v84, v105, v104
    v_fma_f32 v85, v85, v105, v104
    v_fma_f32 v86, v86, v105, v104
    ds_read_b128 v[48:51], v6 offset:40960
    s_waitcnt lgkmcnt(5)
    v_mfma_f32_32x32x16_bf16 v[32:47], a[20:23], v[56:59], v[32:47]
    v_fma_f32 v87, v87, v105, v104
    v_mul_f32 v80, v80, v16
    v_mul_f32 v81, v81, v17
    v_mul_f32 v82, v82, v18
    v_mul_f32 v83, v83, v19
    ds_read_b128 v[52:55], v6 offset:41984
    v_mfma_f32_32x32x16_bf16 v[32:47], a[24:27], v[60:63], v[32:47]
    v_mul_f32 v84, v84, v20
    v_mul_f32 v85, v85, v21
    v_mul_f32 v86, v86, v22
    v_mul_f32 v87, v87, v23
    v_exp_f32 v80, v80
    ds_read_b128 v[56:59], v6 offset:43008
    s_waitcnt lgkmcnt(5)
    v_mfma_f32_32x32x16_bf16 v[32:47], a[28:31], v[64:67], v[32:47]
    v_exp_f32 v81, v81
    v_exp_f32 v82, v82
    v_exp_f32 v83, v83
    v_exp_f32 v84, v84
    v_exp_f32 v85, v85
    ds_read_b128 v[60:63], v6 offset:44032
    v_mfma_f32_32x32x16_bf16 v[32:47], a[32:35], v[68:71], v[32:47]
    v_exp_f32 v86, v86
    v_exp_f32 v87, v87
    v_fma_f32 v80, v80, v106, v106
    v_fma_f32 v81, v81, v106, v106
    v_fma_f32 v82, v82, v106, v106
    ds_read_b128 v[64:67], v6 offset:45056
    s_waitcnt lgkmcnt(5)
    v_mfma_f32_32x32x16_bf16 v[32:47], a[36:39], v[72:75], v[32:47]
    v_fma_f32 v83, v83, v106, v106
    v_fma_f32 v84, v84, v106, v106
    v_fma_f32 v85, v85, v106, v106
    v_fma_f32 v86, v86, v106, v106
    v_fma_f32 v87, v87, v106, v106
    ds_read_b128 v[68:71], v6 offset:46080
    v_mfma_f32_32x32x16_bf16 v[32:47], a[40:43], v[76:79], v[32:47]
    v_rcp_f32 v80, v80
    v_rcp_f32 v81, v81
    v_rcp_f32 v82, v82
    v_rcp_f32 v83, v83
    v_rcp_f32 v84, v84
    ds_read_b128 v[72:75], v6 offset:47104
    s_waitcnt lgkmcnt(5)
    v_mfma_f32_32x32x16_bf16 v[32:47], a[44:47], v[48:51], v[32:47]
    v_rcp_f32 v85, v85
    v_rcp_f32 v86, v86
    v_rcp_f32 v87, v87
    v_mul_f32 v80, v80, v16
    v_mul_f32 v81, v81, v17
    ds_read_b128 v[76:79], v6 offset:48128
    v_mfma_f32_32x32x16_bf16 v[32:47], a[48:51], v[52:55], v[32:47]
    v_mul_f32 v82, v82, v18
    v_mul_f32 v83, v83, v19
    v_mul_f32 v84, v84, v20
    v_mul_f32 v85, v85, v21
    v_mul_f32 v86, v86, v22
    ds_read_b128 v[48:51], v6 offset:49152
    s_waitcnt lgkmcnt(5)
    v_mfma_f32_32x32x16_bf16 v[32:47], a[52:55], v[56:59], v[32:47]
    v_mul_f32 v87, v87, v23
    v_cvt_pk_bf16_f32 v96, v80, v81
    v_cvt_pk_bf16_f32 v97, v82, v83
    v_cvt_pk_bf16_f32 v98, v84, v85
    v_cvt_pk_bf16_f32 v99, v86, v87
    ds_read_b128 v[52:55], v6 offset:50176
    v_mfma_f32_32x32x16_bf16 v[32:47], a[56:59], v[60:63], v[32:47]
    v_mul_f32 v80, v24, v24
    v_mul_f32 v81, v25, v25
    v_mul_f32 v82, v26, v26
    v_mul_f32 v83, v27, v27
    v_mul_f32 v84, v28, v28
    ds_read_b128 v[56:59], v6 offset:51200
    s_waitcnt lgkmcnt(5)
    v_mfma_f32_32x32x16_bf16 v[32:47], a[60:63], v[64:67], v[32:47]
    v_mul_f32 v85, v29, v29
    v_mul_f32 v86, v30, v30
    v_mul_f32 v87, v31, v31
    v_fma_f32 v80, v80, v105, v104
    v_fma_f32 v81, v81, v105, v104
    ds_read_b128 v[60:63], v6 offset:52224
    v_mfma_f32_32x32x16_bf16 v[32:47], a[64:67], v[68:71], v[32:47]
    v_fma_f32 v82, v82, v105, v104
    v_fma_f32 v83, v83, v105, v104
    v_fma_f32 v84, v84, v105, v104
    v_fma_f32 v85, v85, v105, v104
    v_fma_f32 v86, v86, v105, v104
    ds_read_b128 v[64:67], v6 offset:53248
    s_waitcnt lgkmcnt(5)
    v_mfma_f32_32x32x16_bf16 v[32:47], a[68:71], v[72:75], v[32:47]
    v_fma_f32 v87, v87, v105, v104
    v_mul_f32 v80, v80, v24
    v_mul_f32 v81, v81, v25
    v_mul_f32 v82, v82, v26
    v_mul_f32 v83, v83, v27
    ds_read_b32 v114, v8 offset:16
    ds_read_b128 v[68:71], v6 offset:54272
    v_mfma_f32_32x32x16_bf16 v[32:47], a[72:75], v[76:79], v[32:47]
    v_mul_f32 v84, v84, v28
    v_mul_f32 v85, v85, v29
    v_mul_f32 v86, v86, v30
    v_mul_f32 v87, v87, v31
    v_exp_f32 v80, v80
    ds_read_b128 v[72:75], v6 offset:55296
    s_waitcnt lgkmcnt(6)
    v_mfma_f32_32x32x16_bf16 v[32:47], a[76:79], v[48:51], v[32:47]
    v_exp_f32 v81, v81
    v_exp_f32 v82, v82
    v_exp_f32 v83, v83
    v_exp_f32 v84, v84
    v_exp_f32 v85, v85
    ds_read_b128 v[76:79], v6 offset:56320
    v_mfma_f32_32x32x16_bf16 v[32:47], a[80:83], v[52:55], v[32:47]
    v_exp_f32 v86, v86
    v_exp_f32 v87, v87
    v_fma_f32 v80, v80, v106, v106
    v_fma_f32 v81, v81, v106, v106
    v_fma_f32 v82, v82, v106, v106
    ds_read_b128 v[48:51], v6 offset:57344
    s_waitcnt lgkmcnt(6)
    v_mfma_f32_32x32x16_bf16 v[32:47], a[84:87], v[56:59], v[32:47]
    v_fma_f32 v83, v83, v106, v106
    v_fma_f32 v84, v84, v106, v106
    v_fma_f32 v85, v85, v106, v106
    v_fma_f32 v86, v86, v106, v106
    v_fma_f32 v87, v87, v106, v106
    s_waitcnt lgkmcnt(4)
    v_readfirstlane_b32 s98, v114
    s_nop 0
    s_cmp_ge_u32 s98, 4
    s_cbranch_scc1 L_sequential_preLN__linear_attn_block__dense_activation_gelu__prompt_kernel_57
    v_mov_b32 v112, 163728
    s_mov_b32 s99, 0
    s_branch L_sequential_preLN__linear_attn_block__dense_activation_gelu__prompt_kernel_58_f
L_sequential_preLN__linear_attn_block__dense_activation_gelu__prompt_kernel_58:
    s_sleep 1
L_sequential_preLN__linear_attn_block__dense_activation_gelu__prompt_kernel_58_f:
    ds_read_b32 v113, v112
    s_add_u32 s99, s99, 1
    s_waitcnt lgkmcnt(0)
    v_readfirstlane_b32 s98, v113
    s_cmp_gt_u32 s99, 800000
    s_cbranch_scc1 L_sequential_preLN__linear_attn_block__dense_activation_gelu__prompt_kernel_58_x
    s_cmp_lt_u32 s98, 4
    s_cbranch_scc1 L_sequential_preLN__linear_attn_block__dense_activation_gelu__prompt_kernel_58
L_sequential_preLN__linear_attn_block__dense_activation_gelu__prompt_kernel_58_x:
L_sequential_preLN__linear_attn_block__dense_activation_gelu__prompt_kernel_57:
    ds_read_b128 v[52:55], v6 offset:58368
    ds_read_b128 v[108:111], v9 offset:512
    v_mfma_f32_32x32x16_bf16 v[32:47], a[88:91], v[60:63], v[32:47]
    v_rcp_f32 v80, v80
    v_rcp_f32 v81, v81
    v_rcp_f32 v82, v82
    v_rcp_f32 v83, v83
    v_rcp_f32 v84, v84
    ds_read_b128 v[56:59], v7 offset:0
    s_waitcnt lgkmcnt(6)
    v_mfma_f32_32x32x16_bf16 v[32:47], a[92:95], v[64:67], v[32:47]
    v_rcp_f32 v85, v85
    v_rcp_f32 v86, v86
    v_rcp_f32 v87, v87
    v_mul_f32 v80, v80, v24
    v_mul_f32 v81, v81, v25
    ds_read_b128 v[60:63], v7 offset:1024
    v_mfma_f32_32x32x16_bf16 v[32:47], a[96:99], v[68:71], v[32:47]
    v_mul_f32 v82, v82, v26
    v_mul_f32 v83, v83, v27
    v_mul_f32 v84, v84, v28
    v_mul_f32 v85, v85, v29
    v_mul_f32 v86, v86, v30
    ds_read_b128 v[64:67], v7 offset:2048
    s_waitcnt lgkmcnt(6)
    v_mfma_f32_32x32x16_bf16 v[32:47], a[100:103], v[72:75], v[32:47]
    v_mul_f32 v87, v87, v31
    v_cvt_pk_bf16_f32 v100, v80, v81
    v_cvt_pk_bf16_f32 v101, v82, v83
    v_cvt_pk_bf16_f32 v102, v84, v85
    v_cvt_pk_bf16_f32 v103, v86, v87
    ds_read_b128 v[68:71], v7 offset:3072
    v_mfma_f32_32x32x16_bf16 v[32:47], a[104:107], v[76:79], v[32:47]
    ds_read_b128 v[72:75], v7 offset:4096
    s_waitcnt lgkmcnt(5)
    v_mfma_f32_32x32x16_bf16 v[32:47], a[108:111], v[48:51], v[32:47]
    ds_read_b128 v[76:79], v7 offset:5120
    v_mfma_f32_32x32x16_bf16 v[32:47], a[112:115], v[52:55], v[32:47]
    s_mov_b64 exec, 1
    ds_add_u32 v8, v10 offset:28
    s_mov_b64 exec, -1
    ds_read_b128 v[48:51], v7 offset:6144
    s_waitcnt lgkmcnt(6)
    v_mfma_f32_32x32x16_bf16 v[16:31], a[0:3], v[56:59], 0
    ds_read_b128 v[52:55], v7 offset:7168
    v_mfma_f32_32x32x16_bf16 v[16:31], a[4:7], v[60:63], v[16:31]
    ds_read_b128 v[56:59], v7 offset:8192
    s_waitcnt lgkmcnt(6)
    v_mfma_f32_32x32x16_bf16 v[16:31], a[8:11], v[64:67], v[16:31]
    s_nop 0
    v_mul_f32 v80, v32, v32
    v_mul_f32 v81, v33, v33
    v_mul_f32 v82, v34, v34
    v_mul_f32 v83, v35, v35
    v_mul_f32 v84, v36, v36
    ds_read_b128 v[60:63], v7 offset:9216
    v_mfma_f32_32x32x16_bf16 v[16:31], a[12:15], v[68:71], v[16:31]
    v_mul_f32 v85, v37, v37
    v_mul_f32 v86, v38, v38
    v_mul_f32 v87, v39, v39
    v_fma_f32 v80, v80, v109, v108
    v_fma_f32 v81, v81, v109, v108
    ds_read_b128 v[64:67], v7 offset:10240
    s_waitcnt lgkmcnt(6)
    v_mfma_f32_32x32x16_bf16 v[16:31], a[16:19], v[72:75], v[16:31]
    v_fma_f32 v82, v82, v109, v108
    v_fma_f32 v83, v83, v109, v108
    v_fma_f32 v84, v84, v109, v108
    v_fma_f32 v85, v85, v109, v108
    v_fma_f32 v86, v86, v109, v108
    ds_read_b128 v[68:71], v7 offset:11264
    v_mfma_f32_32x32x16_bf16 v[16:31], a[20:23], v[76:79], v[16:31]
    v_fma_f32 v87, v87, v109, v108
    v_mul_f32 v80, v80, v32
    v_mul_f32 v81, v81, v33
    v_mul_f32 v82, v82, v34
    v_mul_f32 v83, v83, v35
    ds_read_b128 v[72:75], v7 offset:12288
    s_waitcnt lgkmcnt(5)
    v_mfma_f32_32x32x16_bf16 v[16:31], a[24:27], v[48:51], v[16:31]
    v_mul_f32 v84, v84, v36
    v_mul_f32 v85, v85, v37
    v_mul_f32 v86, v86, v38
    v_mul_f32 v87, v87, v39
    v_exp_f32 v80, v80
    ds_read_b128 v[76:79], v7 offset:13312
    v_mfma_f32_32x32x16_bf16 v[16:31], a[28:31], v[52:55], v[16:31]
    v_exp_f32 v81, v81
    v_exp_f32 v82, v82
    v_exp_f32 v83, v83
    v_exp_f32 v84, v84
    v_exp_f32 v85, v85
    ds_read_b128 v[48:51], v7 offset:14336
    s_waitcnt lgkmcnt(5)
    v_mfma_f32_32x32x16_bf16 v[16:31], a[32:35], v[56:59], v[16:31]
    v_exp_f32 v86, v86
    v_exp_f32 v87, v87
    v_fma_f32 v80, v80, v110, v110
    v_fma_f32 v81, v81, v110, v110
    v_fma_f32 v82, v82, v110, v110
    ds_read_b128 v[52:55], v7 offset:15360
    v_mfma_f32_32x32x16_bf16 v[16:31], a[36:39], v[60:63], v[16:31]
    v_fma_f32 v83, v83, v110, v110
    v_fma_f32 v84, v84, v110, v110
    v_fma_f32 v85, v85, v110, v110
    v_fma_f32 v86, v86, v110, v110
    v_fma_f32 v87, v87, v110, v110
    ds_read_b128 v[56:59], v7 offset:16384
    s_waitcnt lgkmcnt(5)
    v_mfma_f32_32x32x16_bf16 v[16:31], a[40:43], v[64:67], v[16:31]
    v_rcp_f32 v80, v80
    v_rcp_f32 v81, v81
    v_rcp_f32 v82, v82
    v_rcp_f32 v83, v83
    v_rcp_f32 v84, v84
    ds_read_b128 v[60:63], v7 offset:17408
    v_mfma_f32_32x32x16_bf16 v[16:31], a[44:47], v[68:71], v[16:31]
    v_rcp_f32 v85, v85
    v_rcp_f32 v86, v86
    v_rcp_f32 v87, v87
    v_mul_f32 v80, v80, v32
    v_mul_f32 v81, v81, v33
    ds_read_b128 v[64:67], v7 offset:18432
    s_waitcnt lgkmcnt(5)
    v_mfma_f32_32x32x16_bf16 v[16:31], a[48:51], v[72:75], v[16:31]
    v_mul_f32 v82, v82, v34
    v_mul_f32 v83, v83, v35
    v_mul_f32 v84, v84, v36
    v_mul_f32 v85, v85, v37
    v_mul_f32 v86, v86, v38
    ds_read_b128 v[68:71], v7 offset:19456
    v_mfma_f32_32x32x16_bf16 v[16:31], a[52:55], v[76:79], v[16:31]
    v_mul_f32 v87, v87, v39
    v_cvt_pk_bf16_f32 v88, v80, v81
    v_cvt_pk_bf16_f32 v89, v82, v83
    v_cvt_pk_bf16_f32 v90, v84, v85
    v_cvt_pk_bf16_f32 v91, v86, v87
    ds_read_b128 v[72:75], v7 offset:20480
    s_waitcnt lgkmcnt(5)
    v_mfma_f32_32x32x16_bf16 v[16:31], a[56:59], v[48:51], v[16:31]
    v_mul_f32 v80, v40, v40
    v_mul_f32 v81, v41, v41
    v_mul_f32 v82, v42, v42
    v_mul_f32 v83, v43, v43
    v_mul_f32 v84, v44, v44
    ds_read_b128 v[76:79], v7 offset:21504
    v_mfma_f32_32x32x16_bf16 v[16:31], a[60:63], v[52:55], v[16:31]
    v_mul_f32 v85, v45, v45
    v_mul_f32 v86, v46, v46
    v_mul_f32 v87, v47, v47
    v_fma_f32 v80, v80, v109, v108
    v_fma_f32 v81, v81, v109, v108
    ds_read_b128 v[48:51], v7 offset:22528
    s_waitcnt lgkmcnt(5)
    v_mfma_f32_32x32x16_bf16 v[16:31], a[64:67], v[56:59], v[16:31]
    v_fma_f32 v82, v82, v109, v108
    v_fma_f32 v83, v83, v109, v108
    v_fma_f32 v84, v84, v109, v108
    v_fma_f32 v85, v85, v109, v108
    v_fma_f32 v86, v86, v109, v108
    ds_read_b128 v[52:55], v7 offset:23552
    v_mfma_f32_32x32x16_bf16 v[16:31], a[68:71], v[60:63], v[16:31]
    v_fma_f32 v87, v87, v109, v108
    v_mul_f32 v80, v80, v40
    v_mul_f32 v81, v81, v41
    v_mul_f32 v82, v82, v42
    v_mul_f32 v83, v83, v43
    ds_read_b32 v114, v8 offset:20
    ds_read_b128 v[56:59], v7 offset:24576
    s_waitcnt lgkmcnt(6)
    v_mfma_f32_32x32x16_bf16 v[16:31], a[72:75], v[64:67], v[16:31]
    v_mul_f32 v84, v84, v44
    v_mul_f32 v85, v85, v45
    v_mul_f32 v86, v86, v46
    v_mul_f32 v87, v87, v47
    v_exp_f32 v80, v80
    ds_read_b128 v[60:63], v7 offset:25600
    v_mfma_f32_32x32x16_bf16 v[16:31], a[76:79], v[68:71], v[16:31]
    v_exp_f32 v81, v81
    v_exp_f32 v82, v82
    v_exp_f32 v83, v83
    v_exp_f32 v84, v84
    v_exp_f32 v85, v85
    ds_read_b128 v[64:67], v7 offset:26624
    s_waitcnt lgkmcnt(6)
    v_mfma_f32_32x32x16_bf16 v[16:31], a[80:83], v[72:75], v[16:31]
    v_exp_f32 v86, v86
    v_exp_f32 v87, v87
    v_fma_f32 v80, v80, v110, v110
    v_fma_f32 v81, v81, v110, v110
    v_fma_f32 v82, v82, v110, v110
    ds_read_b128 v[68:71], v7 offset:27648
    v_mfma_f32_32x32x16_bf16 v[16:31], a[84:87], v[76:79], v[16:31]
    v_fma_f32 v83, v83, v110, v110
    v_fma_f32 v84, v84, v110, v110
    v_fma_f32 v85, v85, v110, v110
    v_fma_f32 v86, v86, v110, v110
    v_fma_f32 v87, v87, v110, v110
    s_waitcnt lgkmcnt(4)
    v_readfirstlane_b32 s98, v114
    s_nop 0
    s_cmp_ge_u32 s98, 4
    s_cbranch_scc1 L_sequential_preLN__linear_attn_block__dense_activation_gelu__prompt_kernel_59
    v_mov_b32 v112, 163732
    s_mov_b32 s99, 0
    s_branch L_sequential_preLN__linear_attn_block__dense_activation_gelu__prompt_kernel_60_f
L_sequential_preLN__linear_attn_block__dense_activation_gelu__prompt_kernel_60:
    s_sleep 1
L_sequential_preLN__linear_attn_block__dense_activation_gelu__prompt_kernel_60_f:
    ds_read_b32 v113, v112
    s_add_u32 s99, s99, 1
    s_waitcnt lgkmcnt(0)
    v_readfirstlane_b32 s98, v113
    s_cmp_gt_u32 s99, 800000
    s_cbranch_scc1 L_sequential_preLN__linear_attn_block__dense_activation_gelu__prompt_kernel_60_x
    s_cmp_lt_u32 s98, 4
    s_cbranch_scc1 L_sequential_preLN__linear_attn_block__dense_activation_gelu__prompt_kernel_60
L_sequential_preLN__linear_attn_block__dense_activation_gelu__prompt_kernel_60_x:
L_sequential_preLN__linear_attn_block__dense_activation_gelu__prompt_kernel_59:
    ds_read_b128 v[72:75], v7 offset:28672
    ds_read_b128 v[104:107], v9 offset:1024
    v_mfma_f32_32x32x16_bf16 v[16:31], a[88:91], v[48:51], v[16:31]
    v_rcp_f32 v80, v80
    v_rcp_f32 v81, v81
    v_rcp_f32 v82, v82
    v_rcp_f32 v83, v83
    v_rcp_f32 v84, v84
    ds_read_b128 v[76:79], v7 offset:29696
    v_mfma_f32_32x32x16_bf16 v[16:31], a[92:95], v[52:55], v[16:31]
    v_rcp_f32 v85, v85
    v_rcp_f32 v86, v86
    v_rcp_f32 v87, v87
    v_mul_f32 v80, v80, v40
    v_mul_f32 v81, v81, v41
    ds_read_b128 v[48:51], v7 offset:30720
    s_waitcnt lgkmcnt(6)
    v_mfma_f32_32x32x16_bf16 v[16:31], a[96:99], v[56:59], v[16:31]
    v_mul_f32 v82, v82, v42
    v_mul_f32 v83, v83, v43
    v_mul_f32 v84, v84, v44
    v_mul_f32 v85, v85, v45
    v_mul_f32 v86, v86, v46
    ds_read_b128 v[52:55], v7 offset:31744
    v_mfma_f32_32x32x16_bf16 v[16:31], a[100:103], v[60:63], v[16:31]
    v_mul_f32 v87, v87, v47
    v_cvt_pk_bf16_f32 v92, v80, v81
    v_cvt_pk_bf16_f32 v93, v82, v83
    v_cvt_pk_bf16_f32 v94, v84, v85
    v_cvt_pk_bf16_f32 v95, v86, v87
    ds_read_b128 v[56:59], v7 offset:32768
    s_waitcnt lgkmcnt(6)
    v_mfma_f32_32x32x16_bf16 v[16:31], a[104:107], v[64:67], v[16:31]
    buffer_store_dwordx4 v[96:99], v6, s[44:47], s56 offen offset:0 sc1
    buffer_store_dwordx4 v[100:103], v6, s[44:47], s56 offen offset:1024 sc1
    buffer_store_dwordx4 v[88:91], v6, s[44:47], s57 offen offset:0 sc1
    buffer_store_dwordx4 v[92:95], v6, s[44:47], s57 offen offset:1024 sc1
    ds_read_b128 v[60:63], v7 offset:33792
    v_mfma_f32_32x32x16_bf16 v[16:31], a[108:111], v[68:71], v[16:31]
    ds_read_b128 v[64:67], v7 offset:34816
    s_waitcnt lgkmcnt(5)
    v_mfma_f32_32x32x16_bf16 v[16:31], a[112:115], v[72:75], v[16:31]
    ds_read_b128 v[68:71], v7 offset:35840
    v_mfma_f32_32x32x16_bf16 v[32:47], a[0:3], v[76:79], 0
    ds_read_b128 v[72:75], v7 offset:36864
    s_waitcnt lgkmcnt(5)
    v_mfma_f32_32x32x16_bf16 v[32:47], a[4:7], v[48:51], v[32:47]
    ds_read_b128 v[76:79], v7 offset:37888
    v_mfma_f32_32x32x16_bf16 v[32:47], a[8:11], v[52:55], v[32:47]
    s_nop 4
    v_mul_f32 v80, v16, v16
    v_mul_f32 v81, v17, v17
    v_mul_f32 v82, v18, v18
    v_mul_f32 v83, v19, v19
    v_mul_f32 v84, v20, v20
    ds_read_b128 v[48:51], v7 offset:38912
    s_waitcnt lgkmcnt(5)
    v_mfma_f32_32x32x16_bf16 v[32:47], a[12:15], v[56:59], v[32:47]
    v_mul_f32 v85, v21, v21
    v_mul_f32 v86, v22, v22
    v_mul_f32 v87, v23, v23
    v_fma_f32 v80, v80, v105, v104
    v_fma_f32 v81, v81, v105, v104
    ds_read_b128 v[52:55], v7 offset:39936
    v_mfma_f32_32x32x16_bf16 v[32:47], a[16:19], v[60:63], v[32:47]
    v_fma_f32 v82, v82, v105, v104
    v_fma_f32 v83, v83, v105, v104
    v_fma_f32 v84, v84, v105, v104
    v_fma_f32 v85, v85, v105, v104
    v_fma_f32 v86, v86, v105, v104
    ds_read_b128 v[56:59], v7 offset:40960
    s_waitcnt lgkmcnt(5)
    v_mfma_f32_32x32x16_bf16 v[32:47], a[20:23], v[64:67], v[32:47]
    v_fma_f32 v87, v87, v105, v104
    v_mul_f32 v80, v80, v16
    v_mul_f32 v81, v81, v17
    v_mul_f32 v82, v82, v18
    v_mul_f32 v83, v83, v19
    ds_read_b128 v[60:63], v7 offset:41984
    v_mfma_f32_32x32x16_bf16 v[32:47], a[24:27], v[68:71], v[32:47]
    v_mul_f32 v84, v84, v20
    v_mul_f32 v85, v85, v21
    v_mul_f32 v86, v86, v22
    v_mul_f32 v87, v87, v23
    v_exp_f32 v80, v80
    ds_read_b128 v[64:67], v7 offset:43008
    s_waitcnt lgkmcnt(5)
    v_mfma_f32_32x32x16_bf16 v[32:47], a[28:31], v[72:75], v[32:47]
    v_exp_f32 v81, v81
    v_exp_f32 v82, v82
    v_exp_f32 v83, v83
    v_exp_f32 v84, v84
    v_exp_f32 v85, v85
    ds_read_b128 v[68:71], v7 offset:44032
    v_mfma_f32_32x32x16_bf16 v[32:47], a[32:35], v[76:79], v[32:47]
    v_exp_f32 v86, v86
    v_exp_f32 v87, v87
    v_fma_f32 v80, v80, v106, v106
    v_fma_f32 v81, v81, v106, v106
    v_fma_f32 v82, v82, v106, v106
    ds_read_b128 v[72:75], v7 offset:45056
    s_waitcnt lgkmcnt(5)
    v_mfma_f32_32x32x16_bf16 v[32:47], a[36:39], v[48:51], v[32:47]
    v_fma_f32 v83, v83, v106, v106
    v_fma_f32 v84, v84, v106, v106
    v_fma_f32 v85, v85, v106, v106
    v_fma_f32 v86, v86, v106, v106
    v_fma_f32 v87, v87, v106, v106
    ds_read_b128 v[76:79], v7 offset:46080
    v_mfma_f32_32x32x16_bf16 v[32:47], a[40:43], v[52:55], v[32:47]
    v_rcp_f32 v80, v80
    v_rcp_f32 v81, v81
    v_rcp_f32 v82, v82
    v_rcp_f32 v83, v83
    v_rcp_f32 v84, v84
    ds_read_b128 v[48:51], v7 offset:47104
    s_waitcnt lgkmcnt(5)
    v_mfma_f32_32x32x16_bf16 v[32:47], a[44:47], v[56:59], v[32:47]
    v_rcp_f32 v85, v85
    v_rcp_f32 v86, v86
    v_rcp_f32 v87, v87
    v_mul_f32 v80, v80, v16
    v_mul_f32 v81, v81, v17
    ds_read_b128 v[52:55], v7 offset:48128
    v_mfma_f32_32x32x16_bf16 v[32:47], a[48:51], v[60:63], v[32:47]
    v_mul_f32 v82, v82, v18
    v_mul_f32 v83, v83, v19
    v_mul_f32 v84, v84, v20
    v_mul_f32 v85, v85, v21
    v_mul_f32 v86, v86, v22
    ds_read_b128 v[56:59], v7 offset:49152
    s_waitcnt lgkmcnt(5)
    v_mfma_f32_32x32x16_bf16 v[32:47], a[52:55], v[64:67], v[32:47]
    v_mul_f32 v87, v87, v23
    v_cvt_pk_bf16_f32 v116, v80, v81
    v_cvt_pk_bf16_f32 v117, v82, v83
    v_cvt_pk_bf16_f32 v118, v84, v85
    v_cvt_pk_bf16_f32 v119, v86, v87
    ds_read_b128 v[60:63], v7 offset:50176
    v_mfma_f32_32x32x16_bf16 v[32:47], a[56:59], v[68:71], v[32:47]
    v_mul_f32 v80, v24, v24
    v_mul_f32 v81, v25, v25
    v_mul_f32 v82, v26, v26
    v_mul_f32 v83, v27, v27
    v_mul_f32 v84, v28, v28
    ds_read_b128 v[64:67], v7 offset:51200
    s_waitcnt lgkmcnt(5)
    v_mfma_f32_32x32x16_bf16 v[32:47], a[60:63], v[72:75], v[32:47]
    v_mul_f32 v85, v29, v29
    v_mul_f32 v86, v30, v30
    v_mul_f32 v87, v31, v31
    v_fma_f32 v80, v80, v105, v104
    v_fma_f32 v81, v81, v105, v104
    ds_read_b128 v[68:71], v7 offset:52224
    v_mfma_f32_32x32x16_bf16 v[32:47], a[64:67], v[76:79], v[32:47]
    v_fma_f32 v82, v82, v105, v104
    v_fma_f32 v83, v83, v105, v104
    v_fma_f32 v84, v84, v105, v104
    v_fma_f32 v85, v85, v105, v104
    v_fma_f32 v86, v86, v105, v104
    ds_read_b128 v[72:75], v7 offset:53248
    s_waitcnt lgkmcnt(5)
    v_mfma_f32_32x32x16_bf16 v[32:47], a[68:71], v[48:51], v[32:47]
    v_fma_f32 v87, v87, v105, v104
    v_mul_f32 v80, v80, v24
    v_mul_f32 v81, v81, v25
    v_mul_f32 v82, v82, v26
    v_mul_f32 v83, v83, v27
    ds_read_b128 v[76:79], v7 offset:54272
    v_mfma_f32_32x32x16_bf16 v[32:47], a[72:75], v[52:55], v[32:47]
    v_mul_f32 v84, v84, v28
    v_mul_f32 v85, v85, v29
    v_mul_f32 v86, v86, v30
    v_mul_f32 v87, v87, v31
    v_exp_f32 v80, v80
    ds_read_b128 v[48:51], v7 offset:55296
    s_waitcnt lgkmcnt(5)
    v_mfma_f32_32x32x16_bf16 v[32:47], a[76:79], v[56:59], v[32:47]
    v_exp_f32 v81, v81
    v_exp_f32 v82, v82
    v_exp_f32 v83, v83
    v_exp_f32 v84, v84
    v_exp_f32 v85, v85
    ds_read_b128 v[52:55], v7 offset:56320
    v_mfma_f32_32x32x16_bf16 v[32:47], a[80:83], v[60:63], v[32:47]
    v_exp_f32 v86, v86
    v_exp_f32 v87, v87
    v_fma_f32 v80, v80, v106, v106
    v_fma_f32 v81, v81, v106, v106
    v_fma_f32 v82, v82, v106, v106
    ds_read_b128 v[56:59], v7 offset:57344
    s_waitcnt lgkmcnt(5)
    v_mfma_f32_32x32x16_bf16 v[32:47], a[84:87], v[64:67], v[32:47]
    v_fma_f32 v83, v83, v106, v106
    v_fma_f32 v84, v84, v106, v106
    v_fma_f32 v85, v85, v106, v106
    v_fma_f32 v86, v86, v106, v106
    v_fma_f32 v87, v87, v106, v106
    ds_read_b128 v[60:63], v7 offset:58368
    ds_read_b128 v[108:111], v9 offset:1536
    v_mfma_f32_32x32x16_bf16 v[32:47], a[88:91], v[68:71], v[32:47]
    v_rcp_f32 v80, v80
    v_rcp_f32 v81, v81
    v_rcp_f32 v82, v82
    v_rcp_f32 v83, v83
    v_rcp_f32 v84, v84
    s_waitcnt lgkmcnt(5)
    v_mfma_f32_32x32x16_bf16 v[32:47], a[92:95], v[72:75], v[32:47]
    v_rcp_f32 v85, v85
    v_rcp_f32 v86, v86
    v_rcp_f32 v87, v87
    v_mul_f32 v80, v80, v24
    v_mul_f32 v81, v81, v25
    v_mfma_f32_32x32x16_bf16 v[32:47], a[96:99], v[76:79], v[32:47]
    v_mul_f32 v82, v82, v26
    v_mul_f32 v83, v83, v27
    v_mul_f32 v84, v84, v28
    v_mul_f32 v85, v85, v29
    v_mul_f32 v86, v86, v30
    s_waitcnt lgkmcnt(3)
    v_mfma_f32_32x32x16_bf16 v[32:47], a[100:103], v[48:51], v[32:47]
    v_mul_f32 v87, v87, v31
    v_cvt_pk_bf16_f32 v120, v80, v81
    v_cvt_pk_bf16_f32 v121, v82, v83
    v_cvt_pk_bf16_f32 v122, v84, v85
    v_cvt_pk_bf16_f32 v123, v86, v87
    v_mfma_f32_32x32x16_bf16 v[32:47], a[104:107], v[52:55], v[32:47]
    s_waitcnt lgkmcnt(0)
    v_mfma_f32_32x32x16_bf16 v[32:47], a[108:111], v[56:59], v[32:47]
    v_mfma_f32_32x32x16_bf16 v[32:47], a[112:115], v[60:63], v[32:47]
    s_nop 11
    v_mul_f32 v80, v32, v32
    v_mul_f32 v81, v33, v33
    v_mul_f32 v82, v34, v34
    v_mul_f32 v83, v35, v35
    v_mul_f32 v84, v36, v36
    v_mul_f32 v85, v37, v37
    v_mul_f32 v86, v38, v38
    v_mul_f32 v87, v39, v39
    v_fma_f32 v80, v80, v109, v108
    v_fma_f32 v81, v81, v109, v108
    v_fma_f32 v82, v82, v109, v108
    v_fma_f32 v83, v83, v109, v108
    v_fma_f32 v84, v84, v109, v108
    v_fma_f32 v85, v85, v109, v108
    v_fma_f32 v86, v86, v109, v108
    v_fma_f32 v87, v87, v109, v108
    v_mul_f32 v80, v80, v32
    v_mul_f32 v81, v81, v33
    v_mul_f32 v82, v82, v34
    v_mul_f32 v83, v83, v35
    v_mul_f32 v84, v84, v36
    v_mul_f32 v85, v85, v37
    v_mul_f32 v86, v86, v38
    v_mul_f32 v87, v87, v39
    v_exp_f32 v80, v80
    v_exp_f32 v81, v81
    v_exp_f32 v82, v82
    v_exp_f32 v83, v83
    v_exp_f32 v84, v84
    v_exp_f32 v85, v85
    v_exp_f32 v86, v86
    v_exp_f32 v87, v87
    v_fma_f32 v80, v80, v110, v110
    v_fma_f32 v81, v81, v110, v110
    v_fma_f32 v82, v82, v110, v110
    v_fma_f32 v83, v83, v110, v110
    v_fma_f32 v84, v84, v110, v110
    v_fma_f32 v85, v85, v110, v110
    v_fma_f32 v86, v86, v110, v110
    v_fma_f32 v87, v87, v110, v110
    v_rcp_f32 v80, v80
    v_rcp_f32 v81, v81
    v_rcp_f32 v82, v82
    v_rcp_f32 v83, v83
    v_rcp_f32 v84, v84
    v_rcp_f32 v85, v85
    v_rcp_f32 v86, v86
    v_rcp_f32 v87, v87
    v_mul_f32 v80, v80, v32
    v_mul_f32 v81, v81, v33
    v_mul_f32 v82, v82, v34
    v_mul_f32 v83, v83, v35
    v_mul_f32 v84, v84, v36
    v_mul_f32 v85, v85, v37
    v_mul_f32 v86, v86, v38
    v_mul_f32 v87, v87, v39
    v_cvt_pk_bf16_f32 v48, v80, v81
    v_cvt_pk_bf16_f32 v49, v82, v83
    v_cvt_pk_bf16_f32 v50, v84, v85
    v_cvt_pk_bf16_f32 v51, v86, v87
    buffer_store_dwordx4 v[116:119], v6, s[44:47], s58 offen offset:0 sc1
    buffer_store_dwordx4 v[120:123], v6, s[44:47], s58 offen offset:1024 sc1
    buffer_store_dwordx4 v[48:51], v6, s[44:47], s59 offen offset:0 sc1
    v_mul_f32 v80, v40, v40
    v_mul_f32 v81, v41, v41
    v_mul_f32 v82, v42, v42
    v_mul_f32 v83, v43, v43
    v_mul_f32 v84, v44, v44
    v_mul_f32 v85, v45, v45
    v_mul_f32 v86, v46, v46
    v_mul_f32 v87, v47, v47
    v_fma_f32 v80, v80, v109, v108
    v_fma_f32 v81, v81, v109, v108
    v_fma_f32 v82, v82, v109, v108
    v_fma_f32 v83, v83, v109, v108
    v_fma_f32 v84, v84, v109, v108
    v_fma_f32 v85, v85, v109, v108
    v_fma_f32 v86, v86, v109, v108
    v_fma_f32 v87, v87, v109, v108
    v_mul_f32 v80, v80, v40
    v_mul_f32 v81, v81, v41
    v_mul_f32 v82, v82, v42
    v_mul_f32 v83, v83, v43
    v_mul_f32 v84, v84, v44
    v_mul_f32 v85, v85, v45
    v_mul_f32 v86, v86, v46
    v_mul_f32 v87, v87, v47
    v_exp_f32 v80, v80
    v_exp_f32 v81, v81
    v_exp_f32 v82, v82
    v_exp_f32 v83, v83
    v_exp_f32 v84, v84
    v_exp_f32 v85, v85
    v_exp_f32 v86, v86
    v_exp_f32 v87, v87
    v_fma_f32 v80, v80, v110, v110
    v_fma_f32 v81, v81, v110, v110
    v_fma_f32 v82, v82, v110, v110
    v_fma_f32 v83, v83, v110, v110
    v_fma_f32 v84, v84, v110, v110
    v_fma_f32 v85, v85, v110, v110
    v_fma_f32 v86, v86, v110, v110
    v_fma_f32 v87, v87, v110, v110
    v_rcp_f32 v80, v80
    v_rcp_f32 v81, v81
    v_rcp_f32 v82, v82
    v_rcp_f32 v83, v83
    v_rcp_f32 v84, v84
    v_rcp_f32 v85, v85
    v_rcp_f32 v86, v86
    v_rcp_f32 v87, v87
    v_mul_f32 v80, v80, v40
    v_mul_f32 v81, v81, v41
    v_mul_f32 v82, v82, v42
    v_mul_f32 v83, v83, v43
    v_mul_f32 v84, v84, v44
    v_mul_f32 v85, v85, v45
    v_mul_f32 v86, v86, v46
    v_mul_f32 v87, v87, v47
    v_cvt_pk_bf16_f32 v52, v80, v81
    v_cvt_pk_bf16_f32 v53, v82, v83
    v_cvt_pk_bf16_f32 v54, v84, v85
    v_cvt_pk_bf16_f32 v55, v86, v87
    buffer_store_dwordx4 v[52:55], v6, s[44:47], s59 offen offset:1024 sc1
    s_lshl_b32 s88, s65, 4
    s_lshl_b32 s89, s66, 2
    s_add_u32 s88, s88, s89
    s_add_u32 s88, s88, s67
    v_mov_b32 v112, 0
    v_mov_b32 v113, 1
    s_waitcnt vmcnt(0)
    s_mov_b64 exec, 1
    buffer_store_dword v113, v112, s[4:7], s88 offen offset:1536
    s_mov_b64 exec, -1
    s_lshl_b32 s88, s65, 4
    s_lshl_b32 s89, s66, 2
    s_add_u32 s88, s88, s89
    s_add_u32 s88, s88, s67
    v_mov_b32 v112, 0
    v_mov_b32 v113, 1
    s_mov_b64 exec, 1
    buffer_store_dword v113, v112, s[68:71], s88 offen offset:3584 sc1
    s_mov_b64 exec, -1
LendX_sequential_preLN__linear_attn_block__dense_activation_gelu__prompt_kernel:
    s_endpgm
Lcode_end:
.section .rodata,"a"
.p2align 6
.amdhsa_kernel sequential_preLN__linear_attn_block__dense_activation_gelu__prompt_kernel
  .amdhsa_next_free_vgpr 256
  .amdhsa_next_free_sgpr 102
  .amdhsa_accum_offset 128
  .amdhsa_group_segment_fixed_size 0
  .amdhsa_kernarg_size 88
  .amdhsa_user_sgpr_count 2
  .amdhsa_user_sgpr_kernarg_segment_ptr 1
  .amdhsa_system_sgpr_workgroup_id_x 1
.end_amdhsa_kernel
```
